```python
import torch

def _softmax(x, axis=-1):
    return torch.softmax(x, dim=axis)
def _gelu(x):
    return torch.nn.functional.gelu(x, approximate="tanh")
def _silu(x):
    return torch.nn.functional.silu(x)
def _sigmoid(x):
    return torch.sigmoid(x)
def _layernorm(x, axis=-1, eps=1e-5):
    m = x.mean(dim=axis, keepdim=True)
    v = x.var(dim=axis, keepdim=True, unbiased=False)
    return (x - m) / torch.sqrt(v + eps)
def _scatter_add(tgt, idx, src, axis=0):
    return tgt.clone().index_add_(axis, idx, src)
def _segment_sum(src, seg, n):
    out = torch.zeros((n,) + src.shape[1:], dtype=src.dtype)
    return out.index_add_(0, seg, src)
def _pad(x, pw):
    flat = tuple(v for pair in reversed(pw) for v in pair)
    return torch.nn.functional.pad(x, flat)

kernel_name = 'standalone__low_rank_proj_linformer__decode'

def setup_inputs():

    _w = (lambda a: (lambda t: t.to(torch.bfloat16) if t.is_floating_point() else t)(torch.as_tensor(a)))
    B, H, Sq, Skv, Dh, R = 1, 32, 1, 65536, 128, 16
    return {
        "q": _w((lambda *s: torch.randn(*s, dtype=torch.bfloat16) * 0.8)(B, H, Sq, Dh)),
        "k": _w((lambda *s: torch.randn(*s, dtype=torch.bfloat16) * 0.8)(B, H, Skv, Dh)),
        "v": _w((lambda *s: torch.randn(*s, dtype=torch.bfloat16) * 0.05)(B, H, Skv, Dh)),
        "e_proj": _w((lambda *s: torch.randn(*s, dtype=torch.bfloat16) * 0.8)(R, Skv) * (Skv ** -0.5)),
        "f_proj": _w((lambda *s: torch.randn(*s, dtype=torch.bfloat16) * 0.05)(R, Skv) * (Skv ** -0.5)),
    }

def reference(q, k, v, e_proj, f_proj):
    B, H, Sq, Dh = q.shape
    kp = torch.einsum("rn,bhnd->bhrd", e_proj, k)
    vp = torch.einsum("rn,bhnd->bhrd", f_proj, v)
    scores = torch.einsum("bhqd,bhrd->bhqr", q, kp) * (Dh ** -0.5)
    p = _softmax(scores, axis=-1)
    o = torch.einsum("bhqr,bhrd->bhqd", p, vp)
    return o
```

```asm
; @launch grid=(256,1,1) block=(512,1,1) lds=98304
.amdgcn_target "amdgcn-amd-amdhsa--gfx950"
.text
.globl standalone__low_rank_proj_linformer__decode_kernel
.p2align 8
.type standalone__low_rank_proj_linformer__decode_kernel,@function
standalone__low_rank_proj_linformer__decode_kernel:
    s_cmp_ge_u32 s2, 256
    s_cbranch_scc1 L_done
    s_load_dwordx4 s[4:7], s[0:1], 8
    s_load_dwordx4 s[24:27], s[0:1], 24
    v_lshrrev_b32 v3, 6, v0
    v_and_b32 v0, 63, v0
    v_readfirstlane_b32 s3, v3
    v_lshrrev_b32 v3, 4, v0
    v_and_b32 v2, 15, v0
    v_lshlrev_b32 v1, 11, v3
    v_lshl_add_u32 v1, v2, 4, v1
    v_lshlrev_b32 v2, 17, v2
    v_lshl_add_u32 v2, v3, 4, v2
    s_and_b32 s30, s2, 7
    s_lshr_b32 s32, s2, 3
    s_lshr_b32 s33, s3, 2
    s_and_b32 s34, s3, 3
    s_lshl_b32 s35, s32, 24
    s_mul_i32 s18, s30, 256
    s_mov_b32 s10, 0x1000000
    s_mov_b32 s11, 0x20000
    s_mov_b32 s14, 0x200000
    s_mov_b32 s15, 0x20000
    s_add_u32 s19, s18, s34
    s_lshl_b32 s16, s19, 13
    s_lshl_b32 s17, s19, 6
    s_cmp_eq_u32 s33, 0
    s_waitcnt lgkmcnt(0)
    s_cselect_b32 s8, s4, s6
    s_cselect_b32 s9, s5, s7
    s_cselect_b32 s12, s24, s26
    s_cselect_b32 s13, s25, s27
    s_add_u32 s8, s8, s35
    s_addc_u32 s9, s9, 0
    s_and_b32 s9, s9, 0xffff
    s_and_b32 s13, s13, 0xffff
    buffer_load_dwordx4 v[4:7], v1, s[8:11], s16 offen offset:0 nt
    buffer_load_dwordx4 v[8:11], v1, s[8:11], s16 offen offset:256 nt
    buffer_load_dwordx4 v[12:15], v1, s[8:11], s16 offen offset:512 nt
    buffer_load_dwordx4 v[16:19], v1, s[8:11], s16 offen offset:768 nt
    buffer_load_dwordx4 v[20:23], v1, s[8:11], s16 offen offset:1024 nt
    buffer_load_dwordx4 v[24:27], v1, s[8:11], s16 offen offset:1280 nt
    buffer_load_dwordx4 v[28:31], v1, s[8:11], s16 offen offset:1536 nt
    buffer_load_dwordx4 v[32:35], v1, s[8:11], s16 offen offset:1792 nt
    buffer_load_dwordx4 v[36:39], v2, s[12:15], s17 offen
    s_add_u32 s16, s16, 32768
    s_add_u32 s17, s17, 256
    buffer_load_dwordx4 v[40:43], v1, s[8:11], s16 offen offset:0 nt
    buffer_load_dwordx4 v[44:47], v1, s[8:11], s16 offen offset:256 nt
    buffer_load_dwordx4 v[48:51], v1, s[8:11], s16 offen offset:512 nt
    buffer_load_dwordx4 v[52:55], v1, s[8:11], s16 offen offset:768 nt
    buffer_load_dwordx4 v[56:59], v1, s[8:11], s16 offen offset:1024 nt
    buffer_load_dwordx4 v[60:63], v1, s[8:11], s16 offen offset:1280 nt
    buffer_load_dwordx4 v[64:67], v1, s[8:11], s16 offen offset:1536 nt
    buffer_load_dwordx4 v[68:71], v1, s[8:11], s16 offen offset:1792 nt
    buffer_load_dwordx4 v[72:75], v2, s[12:15], s17 offen
    s_add_u32 s16, s16, 32768
    s_add_u32 s17, s17, 256
    buffer_load_dwordx4 v[76:79], v1, s[8:11], s16 offen offset:0 nt
    buffer_load_dwordx4 v[80:83], v1, s[8:11], s16 offen offset:256 nt
    buffer_load_dwordx4 v[84:87], v1, s[8:11], s16 offen offset:512 nt
    buffer_load_dwordx4 v[88:91], v1, s[8:11], s16 offen offset:768 nt
    buffer_load_dwordx4 v[92:95], v1, s[8:11], s16 offen offset:1024 nt
    buffer_load_dwordx4 v[96:99], v1, s[8:11], s16 offen offset:1280 nt
    buffer_load_dwordx4 v[100:103], v1, s[8:11], s16 offen offset:1536 nt
    buffer_load_dwordx4 v[104:107], v1, s[8:11], s16 offen offset:1792 nt
    buffer_load_dwordx4 v[108:111], v2, s[12:15], s17 offen
    s_load_dwordx2 s[56:57], s[0:1], 0
    s_load_dwordx4 s[60:63], s[0:1], 40
    s_load_dwordx2 s[28:29], s[0:1], 56
    s_mov_b32 s20, 0x05040100
    s_mov_b32 s21, 0x07060302
    s_cmp_lg_u32 s3, 0
    s_cbranch_scc1 L_noinit
    v_lshlrev_b32 v3, 4, v0
    v_mov_b32 v148, 0
    v_mov_b32 v149, 0
    v_mov_b32 v150, 0
    v_mov_b32 v151, 0
    ds_write_b128 v3, v[148:151]
    v_mov_b32 v152, 12
    v_mov_b32 v153, 0
    v_mov_b32 v154, 12
    v_mov_b32 v155, 0
    v_mov_b32 v188, 0
    ds_write_b128 v188, v[152:155]
L_noinit:
    s_lshl_b32 s36, s33, 3
    v_mov_b32 v190, s36
    v_mov_b32 v192, 1
    v_mov_b32 v193, 0
    v_and_b32 v191, 15, v0
    v_lshrrev_b32 v3, 4, v0
    s_cmp_eq_u32 s33, 0
    s_cselect_b64 vcc, -1, 0
    v_cndmask_b32 v191, v3, v191, vcc
    v_lshlrev_b32 v191, 4, v191
    v_mov_b32 v156, 0
    v_mov_b32 v157, 0
    v_mov_b32 v158, 0
    v_mov_b32 v159, 0
    v_mov_b32 v160, 0
    v_mov_b32 v161, 0
    v_mov_b32 v162, 0
    v_mov_b32 v163, 0
    v_mov_b32 v164, 0
    v_mov_b32 v165, 0
    v_mov_b32 v166, 0
    v_mov_b32 v167, 0
    v_mov_b32 v168, 0
    v_mov_b32 v169, 0
    v_mov_b32 v170, 0
    v_mov_b32 v171, 0
    v_mov_b32 v172, 0
    v_mov_b32 v173, 0
    v_mov_b32 v174, 0
    v_mov_b32 v175, 0
    v_mov_b32 v176, 0
    v_mov_b32 v177, 0
    v_mov_b32 v178, 0
    v_mov_b32 v179, 0
    v_mov_b32 v180, 0
    v_mov_b32 v181, 0
    v_mov_b32 v182, 0
    v_mov_b32 v183, 0
    v_mov_b32 v184, 0
    v_mov_b32 v185, 0
    v_mov_b32 v186, 0
    v_mov_b32 v187, 0
    s_waitcnt lgkmcnt(0)
    s_lshl_b32 s36, s32, 13
    s_add_u32 s54, s28, s36
    s_addc_u32 s55, s29, 0
    s_lshl_b32 s36, s33, 8
    s_add_u32 s52, s54, s36
    s_addc_u32 s53, s55, 0
    s_lshl_b32 s36, s32, 8
    s_add_u32 s36, s56, s36
    s_addc_u32 s37, s57, 0
    s_add_u32 s38, s54, 1024
    s_addc_u32 s39, s55, 0
    s_cmp_eq_u32 s33, 0
    s_cselect_b32 s64, s36, s38
    s_cselect_b32 s65, s37, s39
    s_cselect_b32 s66, 256, 64
    s_and_b32 s65, s65, 0xffff
    s_mov_b32 s67, 0x20000
    s_barrier
    s_cmp_lg_u32 s3, 0
    s_cbranch_scc1 L_loop0
    s_lshl_b32 s36, s32, 3
    s_add_u32 s50, s62, s36
    s_addc_u32 s51, s63, 0
    s_mov_b32 s36, 1
    s_atomic_or s36, s[50:51], 0x0 glc
    s_waitcnt lgkmcnt(0)
    s_and_b32 s37, s36, 1
    s_cbranch_scc1 L_poll
    v_mov_b32 v148, 0
    v_lshrrev_b32 v149, 3, v0
    v_lshlrev_b32 v149, 8, v149
    v_and_b32 v150, 7, v0
    v_lshl_add_u32 v149, v150, 2, v149
    v_mov_b32 v152, -1
    v_mov_b32 v153, -1
    v_mov_b32 v154, -1
    v_mov_b32 v155, -1
    v_lshlrev_b32 v150, 4, v0
    v_lshlrev_b32 v151, 2, v0
    v_add_u32 v188, 2048, v150
    global_store_dwordx4 v188, v[152:155], s[54:55] offset:0 sc1
    global_store_dwordx4 v188, v[152:155], s[54:55] offset:1024 sc1
    global_store_dwordx4 v188, v[152:155], s[54:55] offset:2048 sc1
    global_store_dwordx4 v188, v[152:155], s[54:55] offset:3072 sc1
    s_mov_b64 exec, 0xffff
    global_store_dword v151, v152, s[54:55] offset:1024 sc1
    s_mov_b64 exec, 0x1ffff
    global_store_dword v149, v148, s[54:55] sc1
    s_mov_b64 exec, -1
    s_waitcnt vmcnt(0)
    s_mov_b32 s36, 2
    s_atomic_or s36, s[50:51], 0x0 glc
    s_waitcnt lgkmcnt(0)
    s_branch L_setready
L_poll:
    s_mov_b32 s38, 30000
L_poll1:
    s_and_b32 s37, s36, 2
    s_cbranch_scc1 L_setready
    s_sub_u32 s38, s38, 1
    s_cbranch_scc1 L_setready
    s_sleep 16
    s_mov_b32 s36, 0
    s_atomic_or s36, s[50:51], 0x0 glc
    s_waitcnt lgkmcnt(0)
    s_branch L_poll1
L_setready:
    v_mov_b32 v148, 0
    v_mov_b32 v150, 0
    v_mov_b32 v151, 1
    s_mov_b64 exec, 1
    ds_add_u64 v148, v[150:151]
    ds_add_u64 v148, v[150:151] offset:8
    s_mov_b64 exec, -1
L_loop0:
    s_cmp_eq_u32 s33, 0
    s_mov_b32 s95, 252
    s_cselect_b32 s95, s95, 164
L_p1_0:
    s_mov_b64 exec, 1
    ds_add_rtn_u64 v[188:189], v190, v[192:193]
    s_mov_b64 exec, -1
    s_waitcnt lgkmcnt(0)
    v_readfirstlane_b32 s19, v188
    v_readfirstlane_b32 s22, v189
    s_nop 2
    s_add_u32 s36, s18, s19
    s_lshl_b32 s16, s36, 13
    s_lshl_b32 s17, s36, 6
    s_cmp_ge_u32 s19, s95
    s_cbranch_scc1 L_sw_0
    buffer_load_dwordx4 v[112:115], v1, s[8:11], s16 offen offset:0 nt
    buffer_load_dwordx4 v[116:119], v1, s[8:11], s16 offen offset:256 nt
    buffer_load_dwordx4 v[120:123], v1, s[8:11], s16 offen offset:512 nt
    buffer_load_dwordx4 v[124:127], v1, s[8:11], s16 offen offset:768 nt
    buffer_load_dwordx4 v[128:131], v1, s[8:11], s16 offen offset:1024 nt
    buffer_load_dwordx4 v[132:135], v1, s[8:11], s16 offen offset:1280 nt
    buffer_load_dwordx4 v[136:139], v1, s[8:11], s16 offen offset:1536 nt
    buffer_load_dwordx4 v[140:143], v1, s[8:11], s16 offen offset:1792 nt
    buffer_load_dwordx4 v[144:147], v2, s[12:15], s17 offen
L_p1m_0:
    s_waitcnt vmcnt(27)
    v_perm_b32 v148, v8, v4, s20
    v_perm_b32 v149, v16, v12, s20
    v_perm_b32 v150, v24, v20, s20
    v_perm_b32 v151, v32, v28, s20
    v_perm_b32 v152, v8, v4, s21
    v_perm_b32 v153, v16, v12, s21
    v_perm_b32 v154, v24, v20, s21
    v_perm_b32 v155, v32, v28, s21
    v_mfma_f32_16x16x32_bf16 v[156:159], v[36:39], v[148:151], v[156:159]
    v_perm_b32 v148, v9, v5, s20
    v_perm_b32 v149, v17, v13, s20
    v_perm_b32 v150, v25, v21, s20
    v_perm_b32 v151, v33, v29, s20
    v_mfma_f32_16x16x32_bf16 v[160:163], v[36:39], v[152:155], v[160:163]
    v_perm_b32 v152, v9, v5, s21
    v_perm_b32 v153, v17, v13, s21
    v_perm_b32 v154, v25, v21, s21
    v_perm_b32 v155, v33, v29, s21
    v_mfma_f32_16x16x32_bf16 v[164:167], v[36:39], v[148:151], v[164:167]
    v_perm_b32 v148, v10, v6, s20
    v_perm_b32 v149, v18, v14, s20
    v_perm_b32 v150, v26, v22, s20
    v_perm_b32 v151, v34, v30, s20
    v_mfma_f32_16x16x32_bf16 v[168:171], v[36:39], v[152:155], v[168:171]
    v_perm_b32 v152, v10, v6, s21
    v_perm_b32 v153, v18, v14, s21
    v_perm_b32 v154, v26, v22, s21
    v_perm_b32 v155, v34, v30, s21
    v_mfma_f32_16x16x32_bf16 v[172:175], v[36:39], v[148:151], v[172:175]
    v_perm_b32 v148, v11, v7, s20
    v_perm_b32 v149, v19, v15, s20
    v_perm_b32 v150, v27, v23, s20
    v_perm_b32 v151, v35, v31, s20
    v_mfma_f32_16x16x32_bf16 v[176:179], v[36:39], v[152:155], v[176:179]
    v_perm_b32 v152, v11, v7, s21
    v_perm_b32 v153, v19, v15, s21
    v_perm_b32 v154, v27, v23, s21
    v_perm_b32 v155, v35, v31, s21
    v_mfma_f32_16x16x32_bf16 v[180:183], v[36:39], v[148:151], v[180:183]
    s_nop 1
    v_mfma_f32_16x16x32_bf16 v[184:187], v[36:39], v[152:155], v[184:187]
L_p1_1:
    s_mov_b64 exec, 1
    ds_add_rtn_u64 v[188:189], v190, v[192:193]
    s_mov_b64 exec, -1
    s_waitcnt lgkmcnt(0)
    v_readfirstlane_b32 s19, v188
    v_readfirstlane_b32 s22, v189
    s_nop 2
    s_add_u32 s36, s18, s19
    s_lshl_b32 s16, s36, 13
    s_lshl_b32 s17, s36, 6
    s_cmp_ge_u32 s19, s95
    s_cbranch_scc1 L_sw_1
    buffer_load_dwordx4 v[4:7], v1, s[8:11], s16 offen offset:0 nt
    buffer_load_dwordx4 v[8:11], v1, s[8:11], s16 offen offset:256 nt
    buffer_load_dwordx4 v[12:15], v1, s[8:11], s16 offen offset:512 nt
    buffer_load_dwordx4 v[16:19], v1, s[8:11], s16 offen offset:768 nt
    buffer_load_dwordx4 v[20:23], v1, s[8:11], s16 offen offset:1024 nt
    buffer_load_dwordx4 v[24:27], v1, s[8:11], s16 offen offset:1280 nt
    buffer_load_dwordx4 v[28:31], v1, s[8:11], s16 offen offset:1536 nt
    buffer_load_dwordx4 v[32:35], v1, s[8:11], s16 offen offset:1792 nt
    buffer_load_dwordx4 v[36:39], v2, s[12:15], s17 offen
    s_waitcnt vmcnt(27)
    v_perm_b32 v148, v44, v40, s20
    v_perm_b32 v149, v52, v48, s20
    v_perm_b32 v150, v60, v56, s20
    v_perm_b32 v151, v68, v64, s20
    v_perm_b32 v152, v44, v40, s21
    v_perm_b32 v153, v52, v48, s21
    v_perm_b32 v154, v60, v56, s21
    v_perm_b32 v155, v68, v64, s21
    v_mfma_f32_16x16x32_bf16 v[156:159], v[72:75], v[148:151], v[156:159]
    v_perm_b32 v148, v45, v41, s20
    v_perm_b32 v149, v53, v49, s20
    v_perm_b32 v150, v61, v57, s20
    v_perm_b32 v151, v69, v65, s20
    v_mfma_f32_16x16x32_bf16 v[160:163], v[72:75], v[152:155], v[160:163]
    v_perm_b32 v152, v45, v41, s21
    v_perm_b32 v153, v53, v49, s21
    v_perm_b32 v154, v61, v57, s21
    v_perm_b32 v155, v69, v65, s21
    v_mfma_f32_16x16x32_bf16 v[164:167], v[72:75], v[148:151], v[164:167]
    v_perm_b32 v148, v46, v42, s20
    v_perm_b32 v149, v54, v50, s20
    v_perm_b32 v150, v62, v58, s20
    v_perm_b32 v151, v70, v66, s20
    v_mfma_f32_16x16x32_bf16 v[168:171], v[72:75], v[152:155], v[168:171]
    v_perm_b32 v152, v46, v42, s21
    v_perm_b32 v153, v54, v50, s21
    v_perm_b32 v154, v62, v58, s21
    v_perm_b32 v155, v70, v66, s21
    v_mfma_f32_16x16x32_bf16 v[172:175], v[72:75], v[148:151], v[172:175]
    v_perm_b32 v148, v47, v43, s20
    v_perm_b32 v149, v55, v51, s20
    v_perm_b32 v150, v63, v59, s20
    v_perm_b32 v151, v71, v67, s20
    v_mfma_f32_16x16x32_bf16 v[176:179], v[72:75], v[152:155], v[176:179]
    v_perm_b32 v152, v47, v43, s21
    v_perm_b32 v153, v55, v51, s21
    v_perm_b32 v154, v63, v59, s21
    v_perm_b32 v155, v71, v67, s21
    v_mfma_f32_16x16x32_bf16 v[180:183], v[72:75], v[148:151], v[180:183]
    s_nop 1
    v_mfma_f32_16x16x32_bf16 v[184:187], v[72:75], v[152:155], v[184:187]
L_p1_2:
    s_mov_b64 exec, 1
    ds_add_rtn_u64 v[188:189], v190, v[192:193]
    s_mov_b64 exec, -1
    s_waitcnt lgkmcnt(0)
    v_readfirstlane_b32 s19, v188
    v_readfirstlane_b32 s22, v189
    s_nop 2
    s_add_u32 s36, s18, s19
    s_lshl_b32 s16, s36, 13
    s_lshl_b32 s17, s36, 6
    s_cmp_ge_u32 s19, s95
    s_cbranch_scc1 L_sw_2
    buffer_load_dwordx4 v[40:43], v1, s[8:11], s16 offen offset:0 nt
    buffer_load_dwordx4 v[44:47], v1, s[8:11], s16 offen offset:256 nt
    buffer_load_dwordx4 v[48:51], v1, s[8:11], s16 offen offset:512 nt
    buffer_load_dwordx4 v[52:55], v1, s[8:11], s16 offen offset:768 nt
    buffer_load_dwordx4 v[56:59], v1, s[8:11], s16 offen offset:1024 nt
    buffer_load_dwordx4 v[60:63], v1, s[8:11], s16 offen offset:1280 nt
    buffer_load_dwordx4 v[64:67], v1, s[8:11], s16 offen offset:1536 nt
    buffer_load_dwordx4 v[68:71], v1, s[8:11], s16 offen offset:1792 nt
    buffer_load_dwordx4 v[72:75], v2, s[12:15], s17 offen
    s_waitcnt vmcnt(27)
    v_perm_b32 v148, v80, v76, s20
    v_perm_b32 v149, v88, v84, s20
    v_perm_b32 v150, v96, v92, s20
    v_perm_b32 v151, v104, v100, s20
    v_perm_b32 v152, v80, v76, s21
    v_perm_b32 v153, v88, v84, s21
    v_perm_b32 v154, v96, v92, s21
    v_perm_b32 v155, v104, v100, s21
    v_mfma_f32_16x16x32_bf16 v[156:159], v[108:111], v[148:151], v[156:159]
    v_perm_b32 v148, v81, v77, s20
    v_perm_b32 v149, v89, v85, s20
    v_perm_b32 v150, v97, v93, s20
    v_perm_b32 v151, v105, v101, s20
    v_mfma_f32_16x16x32_bf16 v[160:163], v[108:111], v[152:155], v[160:163]
    v_perm_b32 v152, v81, v77, s21
    v_perm_b32 v153, v89, v85, s21
    v_perm_b32 v154, v97, v93, s21
    v_perm_b32 v155, v105, v101, s21
    v_mfma_f32_16x16x32_bf16 v[164:167], v[108:111], v[148:151], v[164:167]
    v_perm_b32 v148, v82, v78, s20
    v_perm_b32 v149, v90, v86, s20
    v_perm_b32 v150, v98, v94, s20
    v_perm_b32 v151, v106, v102, s20
    v_mfma_f32_16x16x32_bf16 v[168:171], v[108:111], v[152:155], v[168:171]
    v_perm_b32 v152, v82, v78, s21
    v_perm_b32 v153, v90, v86, s21
    v_perm_b32 v154, v98, v94, s21
    v_perm_b32 v155, v106, v102, s21
    v_mfma_f32_16x16x32_bf16 v[172:175], v[108:111], v[148:151], v[172:175]
    v_perm_b32 v148, v83, v79, s20
    v_perm_b32 v149, v91, v87, s20
    v_perm_b32 v150, v99, v95, s20
    v_perm_b32 v151, v107, v103, s20
    v_mfma_f32_16x16x32_bf16 v[176:179], v[108:111], v[152:155], v[176:179]
    v_perm_b32 v152, v83, v79, s21
    v_perm_b32 v153, v91, v87, s21
    v_perm_b32 v154, v99, v95, s21
    v_perm_b32 v155, v107, v103, s21
    v_mfma_f32_16x16x32_bf16 v[180:183], v[108:111], v[148:151], v[180:183]
    s_nop 1
    v_mfma_f32_16x16x32_bf16 v[184:187], v[108:111], v[152:155], v[184:187]
L_p1_3:
    s_mov_b64 exec, 1
    ds_add_rtn_u64 v[188:189], v190, v[192:193]
    s_mov_b64 exec, -1
    s_waitcnt lgkmcnt(0)
    v_readfirstlane_b32 s19, v188
    v_readfirstlane_b32 s22, v189
    s_nop 2
    s_add_u32 s36, s18, s19
    s_lshl_b32 s16, s36, 13
    s_lshl_b32 s17, s36, 6
    s_cmp_ge_u32 s19, s95
    s_cbranch_scc1 L_sw_3
    buffer_load_dwordx4 v[76:79], v1, s[8:11], s16 offen offset:0 nt
    buffer_load_dwordx4 v[80:83], v1, s[8:11], s16 offen offset:256 nt
    buffer_load_dwordx4 v[84:87], v1, s[8:11], s16 offen offset:512 nt
    buffer_load_dwordx4 v[88:91], v1, s[8:11], s16 offen offset:768 nt
    buffer_load_dwordx4 v[92:95], v1, s[8:11], s16 offen offset:1024 nt
    buffer_load_dwordx4 v[96:99], v1, s[8:11], s16 offen offset:1280 nt
    buffer_load_dwordx4 v[100:103], v1, s[8:11], s16 offen offset:1536 nt
    buffer_load_dwordx4 v[104:107], v1, s[8:11], s16 offen offset:1792 nt
    buffer_load_dwordx4 v[108:111], v2, s[12:15], s17 offen
    s_waitcnt vmcnt(27)
    v_perm_b32 v148, v116, v112, s20
    v_perm_b32 v149, v124, v120, s20
    v_perm_b32 v150, v132, v128, s20
    v_perm_b32 v151, v140, v136, s20
    v_perm_b32 v152, v116, v112, s21
    v_perm_b32 v153, v124, v120, s21
    v_perm_b32 v154, v132, v128, s21
    v_perm_b32 v155, v140, v136, s21
    v_mfma_f32_16x16x32_bf16 v[156:159], v[144:147], v[148:151], v[156:159]
    v_perm_b32 v148, v117, v113, s20
    v_perm_b32 v149, v125, v121, s20
    v_perm_b32 v150, v133, v129, s20
    v_perm_b32 v151, v141, v137, s20
    v_mfma_f32_16x16x32_bf16 v[160:163], v[144:147], v[152:155], v[160:163]
    v_perm_b32 v152, v117, v113, s21
    v_perm_b32 v153, v125, v121, s21
    v_perm_b32 v154, v133, v129, s21
    v_perm_b32 v155, v141, v137, s21
    v_mfma_f32_16x16x32_bf16 v[164:167], v[144:147], v[148:151], v[164:167]
    v_perm_b32 v148, v118, v114, s20
    v_perm_b32 v149, v126, v122, s20
    v_perm_b32 v150, v134, v130, s20
    v_perm_b32 v151, v142, v138, s20
    v_mfma_f32_16x16x32_bf16 v[168:171], v[144:147], v[152:155], v[168:171]
    v_perm_b32 v152, v118, v114, s21
    v_perm_b32 v153, v126, v122, s21
    v_perm_b32 v154, v134, v130, s21
    v_perm_b32 v155, v142, v138, s21
    v_mfma_f32_16x16x32_bf16 v[172:175], v[144:147], v[148:151], v[172:175]
    v_perm_b32 v148, v119, v115, s20
    v_perm_b32 v149, v127, v123, s20
    v_perm_b32 v150, v135, v131, s20
    v_perm_b32 v151, v143, v139, s20
    v_mfma_f32_16x16x32_bf16 v[176:179], v[144:147], v[152:155], v[176:179]
    v_perm_b32 v152, v119, v115, s21
    v_perm_b32 v153, v127, v123, s21
    v_perm_b32 v154, v135, v131, s21
    v_perm_b32 v155, v143, v139, s21
    v_mfma_f32_16x16x32_bf16 v[180:183], v[144:147], v[148:151], v[180:183]
    s_nop 1
    v_mfma_f32_16x16x32_bf16 v[184:187], v[144:147], v[152:155], v[184:187]
    s_branch L_p1_0
L_sw_0:
    s_cmp_lg_u32 s33, 0
    s_cbranch_scc1 L_swv_0
    s_mov_b32 s80, 0
    s_mov_b32 s82, 0
    s_mov_b32 s23, -1
    s_branch L_p2m_0
L_swv_0:
    s_cmp_lg_u32 s22, 0
    s_cbranch_scc1 L_swok_0
L_swspin_0:
    s_sleep 4
    ds_read_b64 v[188:189], v190
    s_waitcnt lgkmcnt(0)
    v_readfirstlane_b32 s22, v189
    s_nop 2
    s_cmp_eq_u32 s22, 0
    s_cbranch_scc1 L_swspin_0
L_swok_0:
    s_lshl_b32 s58, s30, 2
    s_add_u32 s59, s18, 168
    s_mov_b32 s80, 24
    s_mov_b32 s82, 0
    s_mov_b32 s23, 1
    s_atomic_add s23, s[52:53], s58 glc
    s_branch L_p2m_0
L_sw_1:
    s_cmp_lg_u32 s33, 0
    s_cbranch_scc1 L_swv_1
    s_mov_b32 s80, 0
    s_mov_b32 s82, 0
    s_mov_b32 s23, -1
    s_branch L_p2m_1
L_swv_1:
    s_cmp_lg_u32 s22, 0
    s_cbranch_scc1 L_swok_1
L_swspin_1:
    s_sleep 4
    ds_read_b64 v[188:189], v190
    s_waitcnt lgkmcnt(0)
    v_readfirstlane_b32 s22, v189
    s_nop 2
    s_cmp_eq_u32 s22, 0
    s_cbranch_scc1 L_swspin_1
L_swok_1:
    s_lshl_b32 s58, s30, 2
    s_add_u32 s59, s18, 168
    s_mov_b32 s80, 24
    s_mov_b32 s82, 0
    s_mov_b32 s23, 1
    s_atomic_add s23, s[52:53], s58 glc
    s_branch L_p2m_1
L_sw_2:
    s_cmp_lg_u32 s33, 0
    s_cbranch_scc1 L_swv_2
    s_mov_b32 s80, 0
    s_mov_b32 s82, 0
    s_mov_b32 s23, -1
    s_branch L_p2m_2
L_swv_2:
    s_cmp_lg_u32 s22, 0
    s_cbranch_scc1 L_swok_2
L_swspin_2:
    s_sleep 4
    ds_read_b64 v[188:189], v190
    s_waitcnt lgkmcnt(0)
    v_readfirstlane_b32 s22, v189
    s_nop 2
    s_cmp_eq_u32 s22, 0
    s_cbranch_scc1 L_swspin_2
L_swok_2:
    s_lshl_b32 s58, s30, 2
    s_add_u32 s59, s18, 168
    s_mov_b32 s80, 24
    s_mov_b32 s82, 0
    s_mov_b32 s23, 1
    s_atomic_add s23, s[52:53], s58 glc
    s_branch L_p2m_2
L_sw_3:
    s_cmp_lg_u32 s33, 0
    s_cbranch_scc1 L_swv_3
    s_mov_b32 s80, 0
    s_mov_b32 s82, 0
    s_mov_b32 s23, -1
    s_branch L_p2m_3
L_swv_3:
    s_cmp_lg_u32 s22, 0
    s_cbranch_scc1 L_swok_3
L_swspin_3:
    s_sleep 4
    ds_read_b64 v[188:189], v190
    s_waitcnt lgkmcnt(0)
    v_readfirstlane_b32 s22, v189
    s_nop 2
    s_cmp_eq_u32 s22, 0
    s_cbranch_scc1 L_swspin_3
L_swok_3:
    s_lshl_b32 s58, s30, 2
    s_add_u32 s59, s18, 168
    s_mov_b32 s80, 24
    s_mov_b32 s82, 0
    s_mov_b32 s23, 1
    s_atomic_add s23, s[52:53], s58 glc
    s_branch L_p2m_3
L_p2_0:
    s_cmp_lg_u32 s82, 0
    s_cbranch_scc1 L_p2c_0
    s_waitcnt lgkmcnt(0)
    s_cmp_ge_u32 s23, 24
    s_cbranch_scc1 L_st_0
    s_mov_b32 s82, 10
    s_mov_b32 s37, 0
    s_mov_b32 s83, 4
    s_cmp_ge_u32 s23, 4
    s_cselect_b32 s82, 5, s82
    s_cselect_b32 s37, 36, s37
    s_cmp_ge_u32 s23, 8
    s_cselect_b32 s82, 3, s82
    s_cselect_b32 s37, 52, s37
    s_cmp_ge_u32 s23, 12
    s_cselect_b32 s82, 2, s82
    s_cselect_b32 s37, 60, s37
    s_cmp_ge_u32 s23, 16
    s_cselect_b32 s82, 1, s82
    s_cselect_b32 s37, 64, s37
    s_add_u32 s81, s23, s37
    s_add_u32 s81, s81, s59
L_p2c_0:
    s_lshl_b32 s16, s81, 13
    s_lshl_b32 s17, s81, 6
    s_add_u32 s81, s81, s83
    s_sub_u32 s82, s82, 1
    s_cmp_lg_u32 s82, 0
    s_cbranch_scc1 L_p2m_0
    s_mov_b32 s23, 1
    s_atomic_add s23, s[52:53], s58 glc
L_p2m_0:
    buffer_load_dwordx4 v[112:115], v1, s[8:11], s16 offen offset:0 nt
    buffer_load_dwordx4 v[116:119], v1, s[8:11], s16 offen offset:256 nt
    buffer_load_dwordx4 v[120:123], v1, s[8:11], s16 offen offset:512 nt
    buffer_load_dwordx4 v[124:127], v1, s[8:11], s16 offen offset:768 nt
    buffer_load_dwordx4 v[128:131], v1, s[8:11], s16 offen offset:1024 nt
    buffer_load_dwordx4 v[132:135], v1, s[8:11], s16 offen offset:1280 nt
    buffer_load_dwordx4 v[136:139], v1, s[8:11], s16 offen offset:1536 nt
    buffer_load_dwordx4 v[140:143], v1, s[8:11], s16 offen offset:1792 nt
    buffer_load_dwordx4 v[144:147], v2, s[12:15], s17 offen
    s_waitcnt vmcnt(27)
    v_perm_b32 v148, v8, v4, s20
    v_perm_b32 v149, v16, v12, s20
    v_perm_b32 v150, v24, v20, s20
    v_perm_b32 v151, v32, v28, s20
    v_perm_b32 v152, v8, v4, s21
    v_perm_b32 v153, v16, v12, s21
    v_perm_b32 v154, v24, v20, s21
    v_perm_b32 v155, v32, v28, s21
    v_mfma_f32_16x16x32_bf16 v[156:159], v[36:39], v[148:151], v[156:159]
    v_perm_b32 v148, v9, v5, s20
    v_perm_b32 v149, v17, v13, s20
    v_perm_b32 v150, v25, v21, s20
    v_perm_b32 v151, v33, v29, s20
    v_mfma_f32_16x16x32_bf16 v[160:163], v[36:39], v[152:155], v[160:163]
    v_perm_b32 v152, v9, v5, s21
    v_perm_b32 v153, v17, v13, s21
    v_perm_b32 v154, v25, v21, s21
    v_perm_b32 v155, v33, v29, s21
    v_mfma_f32_16x16x32_bf16 v[164:167], v[36:39], v[148:151], v[164:167]
    v_perm_b32 v148, v10, v6, s20
    v_perm_b32 v149, v18, v14, s20
    v_perm_b32 v150, v26, v22, s20
    v_perm_b32 v151, v34, v30, s20
    v_mfma_f32_16x16x32_bf16 v[168:171], v[36:39], v[152:155], v[168:171]
    v_perm_b32 v152, v10, v6, s21
    v_perm_b32 v153, v18, v14, s21
    v_perm_b32 v154, v26, v22, s21
    v_perm_b32 v155, v34, v30, s21
    v_mfma_f32_16x16x32_bf16 v[172:175], v[36:39], v[148:151], v[172:175]
    v_perm_b32 v148, v11, v7, s20
    v_perm_b32 v149, v19, v15, s20
    v_perm_b32 v150, v27, v23, s20
    v_perm_b32 v151, v35, v31, s20
    v_mfma_f32_16x16x32_bf16 v[176:179], v[36:39], v[152:155], v[176:179]
    v_perm_b32 v152, v11, v7, s21
    v_perm_b32 v153, v19, v15, s21
    v_perm_b32 v154, v27, v23, s21
    v_perm_b32 v155, v35, v31, s21
    v_mfma_f32_16x16x32_bf16 v[180:183], v[36:39], v[148:151], v[180:183]
    s_nop 1
    v_mfma_f32_16x16x32_bf16 v[184:187], v[36:39], v[152:155], v[184:187]
L_p2_1:
    s_cmp_lg_u32 s82, 0
    s_cbranch_scc1 L_p2c_1
    s_waitcnt lgkmcnt(0)
    s_cmp_ge_u32 s23, 24
    s_cbranch_scc1 L_st_1
    s_mov_b32 s82, 10
    s_mov_b32 s37, 0
    s_mov_b32 s83, 4
    s_cmp_ge_u32 s23, 4
    s_cselect_b32 s82, 5, s82
    s_cselect_b32 s37, 36, s37
    s_cmp_ge_u32 s23, 8
    s_cselect_b32 s82, 3, s82
    s_cselect_b32 s37, 52, s37
    s_cmp_ge_u32 s23, 12
    s_cselect_b32 s82, 2, s82
    s_cselect_b32 s37, 60, s37
    s_cmp_ge_u32 s23, 16
    s_cselect_b32 s82, 1, s82
    s_cselect_b32 s37, 64, s37
    s_add_u32 s81, s23, s37
    s_add_u32 s81, s81, s59
L_p2c_1:
    s_lshl_b32 s16, s81, 13
    s_lshl_b32 s17, s81, 6
    s_add_u32 s81, s81, s83
    s_sub_u32 s82, s82, 1
    s_cmp_lg_u32 s82, 0
    s_cbranch_scc1 L_p2m_1
    s_mov_b32 s23, 1
    s_atomic_add s23, s[52:53], s58 glc
L_p2m_1:
    buffer_load_dwordx4 v[4:7], v1, s[8:11], s16 offen offset:0 nt
    buffer_load_dwordx4 v[8:11], v1, s[8:11], s16 offen offset:256 nt
    buffer_load_dwordx4 v[12:15], v1, s[8:11], s16 offen offset:512 nt
    buffer_load_dwordx4 v[16:19], v1, s[8:11], s16 offen offset:768 nt
    buffer_load_dwordx4 v[20:23], v1, s[8:11], s16 offen offset:1024 nt
    buffer_load_dwordx4 v[24:27], v1, s[8:11], s16 offen offset:1280 nt
    buffer_load_dwordx4 v[28:31], v1, s[8:11], s16 offen offset:1536 nt
    buffer_load_dwordx4 v[32:35], v1, s[8:11], s16 offen offset:1792 nt
    buffer_load_dwordx4 v[36:39], v2, s[12:15], s17 offen
    s_waitcnt vmcnt(27)
    v_perm_b32 v148, v44, v40, s20
    v_perm_b32 v149, v52, v48, s20
    v_perm_b32 v150, v60, v56, s20
    v_perm_b32 v151, v68, v64, s20
    v_perm_b32 v152, v44, v40, s21
    v_perm_b32 v153, v52, v48, s21
    v_perm_b32 v154, v60, v56, s21
    v_perm_b32 v155, v68, v64, s21
    v_mfma_f32_16x16x32_bf16 v[156:159], v[72:75], v[148:151], v[156:159]
    v_perm_b32 v148, v45, v41, s20
    v_perm_b32 v149, v53, v49, s20
    v_perm_b32 v150, v61, v57, s20
    v_perm_b32 v151, v69, v65, s20
    v_mfma_f32_16x16x32_bf16 v[160:163], v[72:75], v[152:155], v[160:163]
    v_perm_b32 v152, v45, v41, s21
    v_perm_b32 v153, v53, v49, s21
    v_perm_b32 v154, v61, v57, s21
    v_perm_b32 v155, v69, v65, s21
    v_mfma_f32_16x16x32_bf16 v[164:167], v[72:75], v[148:151], v[164:167]
    v_perm_b32 v148, v46, v42, s20
    v_perm_b32 v149, v54, v50, s20
    v_perm_b32 v150, v62, v58, s20
    v_perm_b32 v151, v70, v66, s20
    v_mfma_f32_16x16x32_bf16 v[168:171], v[72:75], v[152:155], v[168:171]
    v_perm_b32 v152, v46, v42, s21
    v_perm_b32 v153, v54, v50, s21
    v_perm_b32 v154, v62, v58, s21
    v_perm_b32 v155, v70, v66, s21
    v_mfma_f32_16x16x32_bf16 v[172:175], v[72:75], v[148:151], v[172:175]
    v_perm_b32 v148, v47, v43, s20
    v_perm_b32 v149, v55, v51, s20
    v_perm_b32 v150, v63, v59, s20
    v_perm_b32 v151, v71, v67, s20
    v_mfma_f32_16x16x32_bf16 v[176:179], v[72:75], v[152:155], v[176:179]
    v_perm_b32 v152, v47, v43, s21
    v_perm_b32 v153, v55, v51, s21
    v_perm_b32 v154, v63, v59, s21
    v_perm_b32 v155, v71, v67, s21
    v_mfma_f32_16x16x32_bf16 v[180:183], v[72:75], v[148:151], v[180:183]
    s_nop 1
    v_mfma_f32_16x16x32_bf16 v[184:187], v[72:75], v[152:155], v[184:187]
L_p2_2:
    s_cmp_lg_u32 s82, 0
    s_cbranch_scc1 L_p2c_2
    s_waitcnt lgkmcnt(0)
    s_cmp_ge_u32 s23, 24
    s_cbranch_scc1 L_st_2
    s_mov_b32 s82, 10
    s_mov_b32 s37, 0
    s_mov_b32 s83, 4
    s_cmp_ge_u32 s23, 4
    s_cselect_b32 s82, 5, s82
    s_cselect_b32 s37, 36, s37
    s_cmp_ge_u32 s23, 8
    s_cselect_b32 s82, 3, s82
    s_cselect_b32 s37, 52, s37
    s_cmp_ge_u32 s23, 12
    s_cselect_b32 s82, 2, s82
    s_cselect_b32 s37, 60, s37
    s_cmp_ge_u32 s23, 16
    s_cselect_b32 s82, 1, s82
    s_cselect_b32 s37, 64, s37
    s_add_u32 s81, s23, s37
    s_add_u32 s81, s81, s59
L_p2c_2:
    s_lshl_b32 s16, s81, 13
    s_lshl_b32 s17, s81, 6
    s_add_u32 s81, s81, s83
    s_sub_u32 s82, s82, 1
    s_cmp_lg_u32 s82, 0
    s_cbranch_scc1 L_p2m_2
    s_mov_b32 s23, 1
    s_atomic_add s23, s[52:53], s58 glc
L_p2m_2:
    buffer_load_dwordx4 v[40:43], v1, s[8:11], s16 offen offset:0 nt
    buffer_load_dwordx4 v[44:47], v1, s[8:11], s16 offen offset:256 nt
    buffer_load_dwordx4 v[48:51], v1, s[8:11], s16 offen offset:512 nt
    buffer_load_dwordx4 v[52:55], v1, s[8:11], s16 offen offset:768 nt
    buffer_load_dwordx4 v[56:59], v1, s[8:11], s16 offen offset:1024 nt
    buffer_load_dwordx4 v[60:63], v1, s[8:11], s16 offen offset:1280 nt
    buffer_load_dwordx4 v[64:67], v1, s[8:11], s16 offen offset:1536 nt
    buffer_load_dwordx4 v[68:71], v1, s[8:11], s16 offen offset:1792 nt
    buffer_load_dwordx4 v[72:75], v2, s[12:15], s17 offen
    s_waitcnt vmcnt(27)
    v_perm_b32 v148, v80, v76, s20
    v_perm_b32 v149, v88, v84, s20
    v_perm_b32 v150, v96, v92, s20
    v_perm_b32 v151, v104, v100, s20
    v_perm_b32 v152, v80, v76, s21
    v_perm_b32 v153, v88, v84, s21
    v_perm_b32 v154, v96, v92, s21
    v_perm_b32 v155, v104, v100, s21
    v_mfma_f32_16x16x32_bf16 v[156:159], v[108:111], v[148:151], v[156:159]
    v_perm_b32 v148, v81, v77, s20
    v_perm_b32 v149, v89, v85, s20
    v_perm_b32 v150, v97, v93, s20
    v_perm_b32 v151, v105, v101, s20
    v_mfma_f32_16x16x32_bf16 v[160:163], v[108:111], v[152:155], v[160:163]
    v_perm_b32 v152, v81, v77, s21
    v_perm_b32 v153, v89, v85, s21
    v_perm_b32 v154, v97, v93, s21
    v_perm_b32 v155, v105, v101, s21
    v_mfma_f32_16x16x32_bf16 v[164:167], v[108:111], v[148:151], v[164:167]
    v_perm_b32 v148, v82, v78, s20
    v_perm_b32 v149, v90, v86, s20
    v_perm_b32 v150, v98, v94, s20
    v_perm_b32 v151, v106, v102, s20
    v_mfma_f32_16x16x32_bf16 v[168:171], v[108:111], v[152:155], v[168:171]
    v_perm_b32 v152, v82, v78, s21
    v_perm_b32 v153, v90, v86, s21
    v_perm_b32 v154, v98, v94, s21
    v_perm_b32 v155, v106, v102, s21
    v_mfma_f32_16x16x32_bf16 v[172:175], v[108:111], v[148:151], v[172:175]
    v_perm_b32 v148, v83, v79, s20
    v_perm_b32 v149, v91, v87, s20
    v_perm_b32 v150, v99, v95, s20
    v_perm_b32 v151, v107, v103, s20
    v_mfma_f32_16x16x32_bf16 v[176:179], v[108:111], v[152:155], v[176:179]
    v_perm_b32 v152, v83, v79, s21
    v_perm_b32 v153, v91, v87, s21
    v_perm_b32 v154, v99, v95, s21
    v_perm_b32 v155, v107, v103, s21
    v_mfma_f32_16x16x32_bf16 v[180:183], v[108:111], v[148:151], v[180:183]
    s_nop 1
    v_mfma_f32_16x16x32_bf16 v[184:187], v[108:111], v[152:155], v[184:187]
L_p2_3:
    s_cmp_lg_u32 s82, 0
    s_cbranch_scc1 L_p2c_3
    s_waitcnt lgkmcnt(0)
    s_cmp_ge_u32 s23, 24
    s_cbranch_scc1 L_st_3
    s_mov_b32 s82, 10
    s_mov_b32 s37, 0
    s_mov_b32 s83, 4
    s_cmp_ge_u32 s23, 4
    s_cselect_b32 s82, 5, s82
    s_cselect_b32 s37, 36, s37
    s_cmp_ge_u32 s23, 8
    s_cselect_b32 s82, 3, s82
    s_cselect_b32 s37, 52, s37
    s_cmp_ge_u32 s23, 12
    s_cselect_b32 s82, 2, s82
    s_cselect_b32 s37, 60, s37
    s_cmp_ge_u32 s23, 16
    s_cselect_b32 s82, 1, s82
    s_cselect_b32 s37, 64, s37
    s_add_u32 s81, s23, s37
    s_add_u32 s81, s81, s59
L_p2c_3:
    s_lshl_b32 s16, s81, 13
    s_lshl_b32 s17, s81, 6
    s_add_u32 s81, s81, s83
    s_sub_u32 s82, s82, 1
    s_cmp_lg_u32 s82, 0
    s_cbranch_scc1 L_p2m_3
    s_mov_b32 s23, 1
    s_atomic_add s23, s[52:53], s58 glc
L_p2m_3:
    buffer_load_dwordx4 v[76:79], v1, s[8:11], s16 offen offset:0 nt
    buffer_load_dwordx4 v[80:83], v1, s[8:11], s16 offen offset:256 nt
    buffer_load_dwordx4 v[84:87], v1, s[8:11], s16 offen offset:512 nt
    buffer_load_dwordx4 v[88:91], v1, s[8:11], s16 offen offset:768 nt
    buffer_load_dwordx4 v[92:95], v1, s[8:11], s16 offen offset:1024 nt
    buffer_load_dwordx4 v[96:99], v1, s[8:11], s16 offen offset:1280 nt
    buffer_load_dwordx4 v[100:103], v1, s[8:11], s16 offen offset:1536 nt
    buffer_load_dwordx4 v[104:107], v1, s[8:11], s16 offen offset:1792 nt
    buffer_load_dwordx4 v[108:111], v2, s[12:15], s17 offen
    s_waitcnt vmcnt(27)
    v_perm_b32 v148, v116, v112, s20
    v_perm_b32 v149, v124, v120, s20
    v_perm_b32 v150, v132, v128, s20
    v_perm_b32 v151, v140, v136, s20
    v_perm_b32 v152, v116, v112, s21
    v_perm_b32 v153, v124, v120, s21
    v_perm_b32 v154, v132, v128, s21
    v_perm_b32 v155, v140, v136, s21
    v_mfma_f32_16x16x32_bf16 v[156:159], v[144:147], v[148:151], v[156:159]
    v_perm_b32 v148, v117, v113, s20
    v_perm_b32 v149, v125, v121, s20
    v_perm_b32 v150, v133, v129, s20
    v_perm_b32 v151, v141, v137, s20
    v_mfma_f32_16x16x32_bf16 v[160:163], v[144:147], v[152:155], v[160:163]
    v_perm_b32 v152, v117, v113, s21
    v_perm_b32 v153, v125, v121, s21
    v_perm_b32 v154, v133, v129, s21
    v_perm_b32 v155, v141, v137, s21
    v_mfma_f32_16x16x32_bf16 v[164:167], v[144:147], v[148:151], v[164:167]
    v_perm_b32 v148, v118, v114, s20
    v_perm_b32 v149, v126, v122, s20
    v_perm_b32 v150, v134, v130, s20
    v_perm_b32 v151, v142, v138, s20
    v_mfma_f32_16x16x32_bf16 v[168:171], v[144:147], v[152:155], v[168:171]
    v_perm_b32 v152, v118, v114, s21
    v_perm_b32 v153, v126, v122, s21
    v_perm_b32 v154, v134, v130, s21
    v_perm_b32 v155, v142, v138, s21
    v_mfma_f32_16x16x32_bf16 v[172:175], v[144:147], v[148:151], v[172:175]
    v_perm_b32 v148, v119, v115, s20
    v_perm_b32 v149, v127, v123, s20
    v_perm_b32 v150, v135, v131, s20
    v_perm_b32 v151, v143, v139, s20
    v_mfma_f32_16x16x32_bf16 v[176:179], v[144:147], v[152:155], v[176:179]
    v_perm_b32 v152, v119, v115, s21
    v_perm_b32 v153, v127, v123, s21
    v_perm_b32 v154, v135, v131, s21
    v_perm_b32 v155, v143, v139, s21
    v_mfma_f32_16x16x32_bf16 v[180:183], v[144:147], v[148:151], v[180:183]
    s_nop 1
    v_mfma_f32_16x16x32_bf16 v[184:187], v[144:147], v[152:155], v[184:187]
    s_branch L_p2_0
L_st_0:
    s_cmp_eq_u32 s80, 0
    s_cbranch_scc1 L_dr_0
    s_sub_u32 s80, s80, 1
    s_load_dwordx8 s[84:91], s[52:53], 0x0 glc
    s_waitcnt lgkmcnt(0)
    s_mov_b32 s36, s84
    s_mov_b32 s37, 0
    s_cmp_lt_u32 s85, s36
    s_cselect_b32 s36, s85, s36
    s_cselect_b32 s37, 1, s37
    s_cmp_lt_u32 s86, s36
    s_cselect_b32 s36, s86, s36
    s_cselect_b32 s37, 2, s37
    s_cmp_lt_u32 s87, s36
    s_cselect_b32 s36, s87, s36
    s_cselect_b32 s37, 3, s37
    s_cmp_lt_u32 s88, s36
    s_cselect_b32 s36, s88, s36
    s_cselect_b32 s37, 4, s37
    s_cmp_lt_u32 s89, s36
    s_cselect_b32 s36, s89, s36
    s_cselect_b32 s37, 5, s37
    s_cmp_lt_u32 s90, s36
    s_cselect_b32 s36, s90, s36
    s_cselect_b32 s37, 6, s37
    s_cmp_lt_u32 s91, s36
    s_cselect_b32 s36, s91, s36
    s_cselect_b32 s37, 7, s37
    s_cmp_ge_u32 s36, 24
    s_cbranch_scc1 L_dr_0
    s_lshl_b32 s58, s37, 2
    s_mul_i32 s59, s37, 256
    s_add_u32 s59, s59, 168
    s_mov_b32 s23, 1
    s_atomic_add s23, s[52:53], s58 glc
    s_branch L_p2_0
L_st_1:
    s_cmp_eq_u32 s80, 0
    s_cbranch_scc1 L_dr_1
    s_sub_u32 s80, s80, 1
    s_load_dwordx8 s[84:91], s[52:53], 0x0 glc
    s_waitcnt lgkmcnt(0)
    s_mov_b32 s36, s84
    s_mov_b32 s37, 0
    s_cmp_lt_u32 s85, s36
    s_cselect_b32 s36, s85, s36
    s_cselect_b32 s37, 1, s37
    s_cmp_lt_u32 s86, s36
    s_cselect_b32 s36, s86, s36
    s_cselect_b32 s37, 2, s37
    s_cmp_lt_u32 s87, s36
    s_cselect_b32 s36, s87, s36
    s_cselect_b32 s37, 3, s37
    s_cmp_lt_u32 s88, s36
    s_cselect_b32 s36, s88, s36
    s_cselect_b32 s37, 4, s37
    s_cmp_lt_u32 s89, s36
    s_cselect_b32 s36, s89, s36
    s_cselect_b32 s37, 5, s37
    s_cmp_lt_u32 s90, s36
    s_cselect_b32 s36, s90, s36
    s_cselect_b32 s37, 6, s37
    s_cmp_lt_u32 s91, s36
    s_cselect_b32 s36, s91, s36
    s_cselect_b32 s37, 7, s37
    s_cmp_ge_u32 s36, 24
    s_cbranch_scc1 L_dr_1
    s_lshl_b32 s58, s37, 2
    s_mul_i32 s59, s37, 256
    s_add_u32 s59, s59, 168
    s_mov_b32 s23, 1
    s_atomic_add s23, s[52:53], s58 glc
    s_branch L_p2_1
L_st_2:
    s_cmp_eq_u32 s80, 0
    s_cbranch_scc1 L_dr_2
    s_sub_u32 s80, s80, 1
    s_load_dwordx8 s[84:91], s[52:53], 0x0 glc
    s_waitcnt lgkmcnt(0)
    s_mov_b32 s36, s84
    s_mov_b32 s37, 0
    s_cmp_lt_u32 s85, s36
    s_cselect_b32 s36, s85, s36
    s_cselect_b32 s37, 1, s37
    s_cmp_lt_u32 s86, s36
    s_cselect_b32 s36, s86, s36
    s_cselect_b32 s37, 2, s37
    s_cmp_lt_u32 s87, s36
    s_cselect_b32 s36, s87, s36
    s_cselect_b32 s37, 3, s37
    s_cmp_lt_u32 s88, s36
    s_cselect_b32 s36, s88, s36
    s_cselect_b32 s37, 4, s37
    s_cmp_lt_u32 s89, s36
    s_cselect_b32 s36, s89, s36
    s_cselect_b32 s37, 5, s37
    s_cmp_lt_u32 s90, s36
    s_cselect_b32 s36, s90, s36
    s_cselect_b32 s37, 6, s37
    s_cmp_lt_u32 s91, s36
    s_cselect_b32 s36, s91, s36
    s_cselect_b32 s37, 7, s37
    s_cmp_ge_u32 s36, 24
    s_cbranch_scc1 L_dr_2
    s_lshl_b32 s58, s37, 2
    s_mul_i32 s59, s37, 256
    s_add_u32 s59, s59, 168
    s_mov_b32 s23, 1
    s_atomic_add s23, s[52:53], s58 glc
    s_branch L_p2_2
L_st_3:
    s_cmp_eq_u32 s80, 0
    s_cbranch_scc1 L_dr_3
    s_sub_u32 s80, s80, 1
    s_load_dwordx8 s[84:91], s[52:53], 0x0 glc
    s_waitcnt lgkmcnt(0)
    s_mov_b32 s36, s84
    s_mov_b32 s37, 0
    s_cmp_lt_u32 s85, s36
    s_cselect_b32 s36, s85, s36
    s_cselect_b32 s37, 1, s37
    s_cmp_lt_u32 s86, s36
    s_cselect_b32 s36, s86, s36
    s_cselect_b32 s37, 2, s37
    s_cmp_lt_u32 s87, s36
    s_cselect_b32 s36, s87, s36
    s_cselect_b32 s37, 3, s37
    s_cmp_lt_u32 s88, s36
    s_cselect_b32 s36, s88, s36
    s_cselect_b32 s37, 4, s37
    s_cmp_lt_u32 s89, s36
    s_cselect_b32 s36, s89, s36
    s_cselect_b32 s37, 5, s37
    s_cmp_lt_u32 s90, s36
    s_cselect_b32 s36, s90, s36
    s_cselect_b32 s37, 6, s37
    s_cmp_lt_u32 s91, s36
    s_cselect_b32 s36, s91, s36
    s_cselect_b32 s37, 7, s37
    s_cmp_ge_u32 s36, 24
    s_cbranch_scc1 L_dr_3
    s_lshl_b32 s58, s37, 2
    s_mul_i32 s59, s37, 256
    s_add_u32 s59, s59, 168
    s_mov_b32 s23, 1
    s_atomic_add s23, s[52:53], s58 glc
    s_branch L_p2_3
L_dr_0:
    buffer_load_dwordx4 v[194:197], v191, s[64:67], 0 offen sc1
    s_waitcnt vmcnt(19)
    v_perm_b32 v148, v8, v4, s20
    v_perm_b32 v149, v16, v12, s20
    v_perm_b32 v150, v24, v20, s20
    v_perm_b32 v151, v32, v28, s20
    v_perm_b32 v152, v8, v4, s21
    v_perm_b32 v153, v16, v12, s21
    v_perm_b32 v154, v24, v20, s21
    v_perm_b32 v155, v32, v28, s21
    v_mfma_f32_16x16x32_bf16 v[156:159], v[36:39], v[148:151], v[156:159]
    v_perm_b32 v148, v9, v5, s20
    v_perm_b32 v149, v17, v13, s20
    v_perm_b32 v150, v25, v21, s20
    v_perm_b32 v151, v33, v29, s20
    v_mfma_f32_16x16x32_bf16 v[160:163], v[36:39], v[152:155], v[160:163]
    v_perm_b32 v152, v9, v5, s21
    v_perm_b32 v153, v17, v13, s21
    v_perm_b32 v154, v25, v21, s21
    v_perm_b32 v155, v33, v29, s21
    v_mfma_f32_16x16x32_bf16 v[164:167], v[36:39], v[148:151], v[164:167]
    v_perm_b32 v148, v10, v6, s20
    v_perm_b32 v149, v18, v14, s20
    v_perm_b32 v150, v26, v22, s20
    v_perm_b32 v151, v34, v30, s20
    v_mfma_f32_16x16x32_bf16 v[168:171], v[36:39], v[152:155], v[168:171]
    v_perm_b32 v152, v10, v6, s21
    v_perm_b32 v153, v18, v14, s21
    v_perm_b32 v154, v26, v22, s21
    v_perm_b32 v155, v34, v30, s21
    v_mfma_f32_16x16x32_bf16 v[172:175], v[36:39], v[148:151], v[172:175]
    v_perm_b32 v148, v11, v7, s20
    v_perm_b32 v149, v19, v15, s20
    v_perm_b32 v150, v27, v23, s20
    v_perm_b32 v151, v35, v31, s20
    v_mfma_f32_16x16x32_bf16 v[176:179], v[36:39], v[152:155], v[176:179]
    v_perm_b32 v152, v11, v7, s21
    v_perm_b32 v153, v19, v15, s21
    v_perm_b32 v154, v27, v23, s21
    v_perm_b32 v155, v35, v31, s21
    v_mfma_f32_16x16x32_bf16 v[180:183], v[36:39], v[148:151], v[180:183]
    s_nop 1
    v_mfma_f32_16x16x32_bf16 v[184:187], v[36:39], v[152:155], v[184:187]
    s_waitcnt vmcnt(10)
    v_perm_b32 v148, v44, v40, s20
    v_perm_b32 v149, v52, v48, s20
    v_perm_b32 v150, v60, v56, s20
    v_perm_b32 v151, v68, v64, s20
    v_perm_b32 v152, v44, v40, s21
    v_perm_b32 v153, v52, v48, s21
    v_perm_b32 v154, v60, v56, s21
    v_perm_b32 v155, v68, v64, s21
    v_mfma_f32_16x16x32_bf16 v[156:159], v[72:75], v[148:151], v[156:159]
    v_perm_b32 v148, v45, v41, s20
    v_perm_b32 v149, v53, v49, s20
    v_perm_b32 v150, v61, v57, s20
    v_perm_b32 v151, v69, v65, s20
    v_mfma_f32_16x16x32_bf16 v[160:163], v[72:75], v[152:155], v[160:163]
    v_perm_b32 v152, v45, v41, s21
    v_perm_b32 v153, v53, v49, s21
    v_perm_b32 v154, v61, v57, s21
    v_perm_b32 v155, v69, v65, s21
    v_mfma_f32_16x16x32_bf16 v[164:167], v[72:75], v[148:151], v[164:167]
    v_perm_b32 v148, v46, v42, s20
    v_perm_b32 v149, v54, v50, s20
    v_perm_b32 v150, v62, v58, s20
    v_perm_b32 v151, v70, v66, s20
    v_mfma_f32_16x16x32_bf16 v[168:171], v[72:75], v[152:155], v[168:171]
    v_perm_b32 v152, v46, v42, s21
    v_perm_b32 v153, v54, v50, s21
    v_perm_b32 v154, v62, v58, s21
    v_perm_b32 v155, v70, v66, s21
    v_mfma_f32_16x16x32_bf16 v[172:175], v[72:75], v[148:151], v[172:175]
    v_perm_b32 v148, v47, v43, s20
    v_perm_b32 v149, v55, v51, s20
    v_perm_b32 v150, v63, v59, s20
    v_perm_b32 v151, v71, v67, s20
    v_mfma_f32_16x16x32_bf16 v[176:179], v[72:75], v[152:155], v[176:179]
    v_perm_b32 v152, v47, v43, s21
    v_perm_b32 v153, v55, v51, s21
    v_perm_b32 v154, v63, v59, s21
    v_perm_b32 v155, v71, v67, s21
    v_mfma_f32_16x16x32_bf16 v[180:183], v[72:75], v[148:151], v[180:183]
    s_nop 1
    v_mfma_f32_16x16x32_bf16 v[184:187], v[72:75], v[152:155], v[184:187]
    s_waitcnt vmcnt(1)
    v_perm_b32 v148, v80, v76, s20
    v_perm_b32 v149, v88, v84, s20
    v_perm_b32 v150, v96, v92, s20
    v_perm_b32 v151, v104, v100, s20
    v_perm_b32 v152, v80, v76, s21
    v_perm_b32 v153, v88, v84, s21
    v_perm_b32 v154, v96, v92, s21
    v_perm_b32 v155, v104, v100, s21
    v_mfma_f32_16x16x32_bf16 v[156:159], v[108:111], v[148:151], v[156:159]
    v_perm_b32 v148, v81, v77, s20
    v_perm_b32 v149, v89, v85, s20
    v_perm_b32 v150, v97, v93, s20
    v_perm_b32 v151, v105, v101, s20
    v_mfma_f32_16x16x32_bf16 v[160:163], v[108:111], v[152:155], v[160:163]
    v_perm_b32 v152, v81, v77, s21
    v_perm_b32 v153, v89, v85, s21
    v_perm_b32 v154, v97, v93, s21
    v_perm_b32 v155, v105, v101, s21
    v_mfma_f32_16x16x32_bf16 v[164:167], v[108:111], v[148:151], v[164:167]
    v_perm_b32 v148, v82, v78, s20
    v_perm_b32 v149, v90, v86, s20
    v_perm_b32 v150, v98, v94, s20
    v_perm_b32 v151, v106, v102, s20
    v_mfma_f32_16x16x32_bf16 v[168:171], v[108:111], v[152:155], v[168:171]
    v_perm_b32 v152, v82, v78, s21
    v_perm_b32 v153, v90, v86, s21
    v_perm_b32 v154, v98, v94, s21
    v_perm_b32 v155, v106, v102, s21
    v_mfma_f32_16x16x32_bf16 v[172:175], v[108:111], v[148:151], v[172:175]
    v_perm_b32 v148, v83, v79, s20
    v_perm_b32 v149, v91, v87, s20
    v_perm_b32 v150, v99, v95, s20
    v_perm_b32 v151, v107, v103, s20
    v_mfma_f32_16x16x32_bf16 v[176:179], v[108:111], v[152:155], v[176:179]
    v_perm_b32 v152, v83, v79, s21
    v_perm_b32 v153, v91, v87, s21
    v_perm_b32 v154, v99, v95, s21
    v_perm_b32 v155, v107, v103, s21
    v_mfma_f32_16x16x32_bf16 v[180:183], v[108:111], v[148:151], v[180:183]
    s_nop 1
    v_mfma_f32_16x16x32_bf16 v[184:187], v[108:111], v[152:155], v[184:187]
    s_branch L_loopdone
L_dr_1:
    buffer_load_dwordx4 v[194:197], v191, s[64:67], 0 offen sc1
    s_waitcnt vmcnt(19)
    v_perm_b32 v148, v44, v40, s20
    v_perm_b32 v149, v52, v48, s20
    v_perm_b32 v150, v60, v56, s20
    v_perm_b32 v151, v68, v64, s20
    v_perm_b32 v152, v44, v40, s21
    v_perm_b32 v153, v52, v48, s21
    v_perm_b32 v154, v60, v56, s21
    v_perm_b32 v155, v68, v64, s21
    v_mfma_f32_16x16x32_bf16 v[156:159], v[72:75], v[148:151], v[156:159]
    v_perm_b32 v148, v45, v41, s20
    v_perm_b32 v149, v53, v49, s20
    v_perm_b32 v150, v61, v57, s20
    v_perm_b32 v151, v69, v65, s20
    v_mfma_f32_16x16x32_bf16 v[160:163], v[72:75], v[152:155], v[160:163]
    v_perm_b32 v152, v45, v41, s21
    v_perm_b32 v153, v53, v49, s21
    v_perm_b32 v154, v61, v57, s21
    v_perm_b32 v155, v69, v65, s21
    v_mfma_f32_16x16x32_bf16 v[164:167], v[72:75], v[148:151], v[164:167]
    v_perm_b32 v148, v46, v42, s20
    v_perm_b32 v149, v54, v50, s20
    v_perm_b32 v150, v62, v58, s20
    v_perm_b32 v151, v70, v66, s20
    v_mfma_f32_16x16x32_bf16 v[168:171], v[72:75], v[152:155], v[168:171]
    v_perm_b32 v152, v46, v42, s21
    v_perm_b32 v153, v54, v50, s21
    v_perm_b32 v154, v62, v58, s21
    v_perm_b32 v155, v70, v66, s21
    v_mfma_f32_16x16x32_bf16 v[172:175], v[72:75], v[148:151], v[172:175]
    v_perm_b32 v148, v47, v43, s20
    v_perm_b32 v149, v55, v51, s20
    v_perm_b32 v150, v63, v59, s20
    v_perm_b32 v151, v71, v67, s20
    v_mfma_f32_16x16x32_bf16 v[176:179], v[72:75], v[152:155], v[176:179]
    v_perm_b32 v152, v47, v43, s21
    v_perm_b32 v153, v55, v51, s21
    v_perm_b32 v154, v63, v59, s21
    v_perm_b32 v155, v71, v67, s21
    v_mfma_f32_16x16x32_bf16 v[180:183], v[72:75], v[148:151], v[180:183]
    s_nop 1
    v_mfma_f32_16x16x32_bf16 v[184:187], v[72:75], v[152:155], v[184:187]
    s_waitcnt vmcnt(10)
    v_perm_b32 v148, v80, v76, s20
    v_perm_b32 v149, v88, v84, s20
    v_perm_b32 v150, v96, v92, s20
    v_perm_b32 v151, v104, v100, s20
    v_perm_b32 v152, v80, v76, s21
    v_perm_b32 v153, v88, v84, s21
    v_perm_b32 v154, v96, v92, s21
    v_perm_b32 v155, v104, v100, s21
    v_mfma_f32_16x16x32_bf16 v[156:159], v[108:111], v[148:151], v[156:159]
    v_perm_b32 v148, v81, v77, s20
    v_perm_b32 v149, v89, v85, s20
    v_perm_b32 v150, v97, v93, s20
    v_perm_b32 v151, v105, v101, s20
    v_mfma_f32_16x16x32_bf16 v[160:163], v[108:111], v[152:155], v[160:163]
    v_perm_b32 v152, v81, v77, s21
    v_perm_b32 v153, v89, v85, s21
    v_perm_b32 v154, v97, v93, s21
    v_perm_b32 v155, v105, v101, s21
    v_mfma_f32_16x16x32_bf16 v[164:167], v[108:111], v[148:151], v[164:167]
    v_perm_b32 v148, v82, v78, s20
    v_perm_b32 v149, v90, v86, s20
    v_perm_b32 v150, v98, v94, s20
    v_perm_b32 v151, v106, v102, s20
    v_mfma_f32_16x16x32_bf16 v[168:171], v[108:111], v[152:155], v[168:171]
    v_perm_b32 v152, v82, v78, s21
    v_perm_b32 v153, v90, v86, s21
    v_perm_b32 v154, v98, v94, s21
    v_perm_b32 v155, v106, v102, s21
    v_mfma_f32_16x16x32_bf16 v[172:175], v[108:111], v[148:151], v[172:175]
    v_perm_b32 v148, v83, v79, s20
    v_perm_b32 v149, v91, v87, s20
    v_perm_b32 v150, v99, v95, s20
    v_perm_b32 v151, v107, v103, s20
    v_mfma_f32_16x16x32_bf16 v[176:179], v[108:111], v[152:155], v[176:179]
    v_perm_b32 v152, v83, v79, s21
    v_perm_b32 v153, v91, v87, s21
    v_perm_b32 v154, v99, v95, s21
    v_perm_b32 v155, v107, v103, s21
    v_mfma_f32_16x16x32_bf16 v[180:183], v[108:111], v[148:151], v[180:183]
    s_nop 1
    v_mfma_f32_16x16x32_bf16 v[184:187], v[108:111], v[152:155], v[184:187]
    s_waitcnt vmcnt(1)
    v_perm_b32 v148, v116, v112, s20
    v_perm_b32 v149, v124, v120, s20
    v_perm_b32 v150, v132, v128, s20
    v_perm_b32 v151, v140, v136, s20
    v_perm_b32 v152, v116, v112, s21
    v_perm_b32 v153, v124, v120, s21
    v_perm_b32 v154, v132, v128, s21
    v_perm_b32 v155, v140, v136, s21
    v_mfma_f32_16x16x32_bf16 v[156:159], v[144:147], v[148:151], v[156:159]
    v_perm_b32 v148, v117, v113, s20
    v_perm_b32 v149, v125, v121, s20
    v_perm_b32 v150, v133, v129, s20
    v_perm_b32 v151, v141, v137, s20
    v_mfma_f32_16x16x32_bf16 v[160:163], v[144:147], v[152:155], v[160:163]
    v_perm_b32 v152, v117, v113, s21
    v_perm_b32 v153, v125, v121, s21
    v_perm_b32 v154, v133, v129, s21
    v_perm_b32 v155, v141, v137, s21
    v_mfma_f32_16x16x32_bf16 v[164:167], v[144:147], v[148:151], v[164:167]
    v_perm_b32 v148, v118, v114, s20
    v_perm_b32 v149, v126, v122, s20
    v_perm_b32 v150, v134, v130, s20
    v_perm_b32 v151, v142, v138, s20
    v_mfma_f32_16x16x32_bf16 v[168:171], v[144:147], v[152:155], v[168:171]
    v_perm_b32 v152, v118, v114, s21
    v_perm_b32 v153, v126, v122, s21
    v_perm_b32 v154, v134, v130, s21
    v_perm_b32 v155, v142, v138, s21
    v_mfma_f32_16x16x32_bf16 v[172:175], v[144:147], v[148:151], v[172:175]
    v_perm_b32 v148, v119, v115, s20
    v_perm_b32 v149, v127, v123, s20
    v_perm_b32 v150, v135, v131, s20
    v_perm_b32 v151, v143, v139, s20
    v_mfma_f32_16x16x32_bf16 v[176:179], v[144:147], v[152:155], v[176:179]
    v_perm_b32 v152, v119, v115, s21
    v_perm_b32 v153, v127, v123, s21
    v_perm_b32 v154, v135, v131, s21
    v_perm_b32 v155, v143, v139, s21
    v_mfma_f32_16x16x32_bf16 v[180:183], v[144:147], v[148:151], v[180:183]
    s_nop 1
    v_mfma_f32_16x16x32_bf16 v[184:187], v[144:147], v[152:155], v[184:187]
    s_branch L_loopdone
L_dr_2:
    buffer_load_dwordx4 v[194:197], v191, s[64:67], 0 offen sc1
    s_waitcnt vmcnt(19)
    v_perm_b32 v148, v80, v76, s20
    v_perm_b32 v149, v88, v84, s20
    v_perm_b32 v150, v96, v92, s20
    v_perm_b32 v151, v104, v100, s20
    v_perm_b32 v152, v80, v76, s21
    v_perm_b32 v153, v88, v84, s21
    v_perm_b32 v154, v96, v92, s21
    v_perm_b32 v155, v104, v100, s21
    v_mfma_f32_16x16x32_bf16 v[156:159], v[108:111], v[148:151], v[156:159]
    v_perm_b32 v148, v81, v77, s20
    v_perm_b32 v149, v89, v85, s20
    v_perm_b32 v150, v97, v93, s20
    v_perm_b32 v151, v105, v101, s20
    v_mfma_f32_16x16x32_bf16 v[160:163], v[108:111], v[152:155], v[160:163]
    v_perm_b32 v152, v81, v77, s21
    v_perm_b32 v153, v89, v85, s21
    v_perm_b32 v154, v97, v93, s21
    v_perm_b32 v155, v105, v101, s21
    v_mfma_f32_16x16x32_bf16 v[164:167], v[108:111], v[148:151], v[164:167]
    v_perm_b32 v148, v82, v78, s20
    v_perm_b32 v149, v90, v86, s20
    v_perm_b32 v150, v98, v94, s20
    v_perm_b32 v151, v106, v102, s20
    v_mfma_f32_16x16x32_bf16 v[168:171], v[108:111], v[152:155], v[168:171]
    v_perm_b32 v152, v82, v78, s21
    v_perm_b32 v153, v90, v86, s21
    v_perm_b32 v154, v98, v94, s21
    v_perm_b32 v155, v106, v102, s21
    v_mfma_f32_16x16x32_bf16 v[172:175], v[108:111], v[148:151], v[172:175]
    v_perm_b32 v148, v83, v79, s20
    v_perm_b32 v149, v91, v87, s20
    v_perm_b32 v150, v99, v95, s20
    v_perm_b32 v151, v107, v103, s20
    v_mfma_f32_16x16x32_bf16 v[176:179], v[108:111], v[152:155], v[176:179]
    v_perm_b32 v152, v83, v79, s21
    v_perm_b32 v153, v91, v87, s21
    v_perm_b32 v154, v99, v95, s21
    v_perm_b32 v155, v107, v103, s21
    v_mfma_f32_16x16x32_bf16 v[180:183], v[108:111], v[148:151], v[180:183]
    s_nop 1
    v_mfma_f32_16x16x32_bf16 v[184:187], v[108:111], v[152:155], v[184:187]
    s_waitcnt vmcnt(10)
    v_perm_b32 v148, v116, v112, s20
    v_perm_b32 v149, v124, v120, s20
    v_perm_b32 v150, v132, v128, s20
    v_perm_b32 v151, v140, v136, s20
    v_perm_b32 v152, v116, v112, s21
    v_perm_b32 v153, v124, v120, s21
    v_perm_b32 v154, v132, v128, s21
    v_perm_b32 v155, v140, v136, s21
    v_mfma_f32_16x16x32_bf16 v[156:159], v[144:147], v[148:151], v[156:159]
    v_perm_b32 v148, v117, v113, s20
    v_perm_b32 v149, v125, v121, s20
    v_perm_b32 v150, v133, v129, s20
    v_perm_b32 v151, v141, v137, s20
    v_mfma_f32_16x16x32_bf16 v[160:163], v[144:147], v[152:155], v[160:163]
    v_perm_b32 v152, v117, v113, s21
    v_perm_b32 v153, v125, v121, s21
    v_perm_b32 v154, v133, v129, s21
    v_perm_b32 v155, v141, v137, s21
    v_mfma_f32_16x16x32_bf16 v[164:167], v[144:147], v[148:151], v[164:167]
    v_perm_b32 v148, v118, v114, s20
    v_perm_b32 v149, v126, v122, s20
    v_perm_b32 v150, v134, v130, s20
    v_perm_b32 v151, v142, v138, s20
    v_mfma_f32_16x16x32_bf16 v[168:171], v[144:147], v[152:155], v[168:171]
    v_perm_b32 v152, v118, v114, s21
    v_perm_b32 v153, v126, v122, s21
    v_perm_b32 v154, v134, v130, s21
    v_perm_b32 v155, v142, v138, s21
    v_mfma_f32_16x16x32_bf16 v[172:175], v[144:147], v[148:151], v[172:175]
    v_perm_b32 v148, v119, v115, s20
    v_perm_b32 v149, v127, v123, s20
    v_perm_b32 v150, v135, v131, s20
    v_perm_b32 v151, v143, v139, s20
    v_mfma_f32_16x16x32_bf16 v[176:179], v[144:147], v[152:155], v[176:179]
    v_perm_b32 v152, v119, v115, s21
    v_perm_b32 v153, v127, v123, s21
    v_perm_b32 v154, v135, v131, s21
    v_perm_b32 v155, v143, v139, s21
    v_mfma_f32_16x16x32_bf16 v[180:183], v[144:147], v[148:151], v[180:183]
    s_nop 1
    v_mfma_f32_16x16x32_bf16 v[184:187], v[144:147], v[152:155], v[184:187]
    s_waitcnt vmcnt(1)
    v_perm_b32 v148, v8, v4, s20
    v_perm_b32 v149, v16, v12, s20
    v_perm_b32 v150, v24, v20, s20
    v_perm_b32 v151, v32, v28, s20
    v_perm_b32 v152, v8, v4, s21
    v_perm_b32 v153, v16, v12, s21
    v_perm_b32 v154, v24, v20, s21
    v_perm_b32 v155, v32, v28, s21
    v_mfma_f32_16x16x32_bf16 v[156:159], v[36:39], v[148:151], v[156:159]
    v_perm_b32 v148, v9, v5, s20
    v_perm_b32 v149, v17, v13, s20
    v_perm_b32 v150, v25, v21, s20
    v_perm_b32 v151, v33, v29, s20
    v_mfma_f32_16x16x32_bf16 v[160:163], v[36:39], v[152:155], v[160:163]
    v_perm_b32 v152, v9, v5, s21
    v_perm_b32 v153, v17, v13, s21
    v_perm_b32 v154, v25, v21, s21
    v_perm_b32 v155, v33, v29, s21
    v_mfma_f32_16x16x32_bf16 v[164:167], v[36:39], v[148:151], v[164:167]
    v_perm_b32 v148, v10, v6, s20
    v_perm_b32 v149, v18, v14, s20
    v_perm_b32 v150, v26, v22, s20
    v_perm_b32 v151, v34, v30, s20
    v_mfma_f32_16x16x32_bf16 v[168:171], v[36:39], v[152:155], v[168:171]
    v_perm_b32 v152, v10, v6, s21
    v_perm_b32 v153, v18, v14, s21
    v_perm_b32 v154, v26, v22, s21
    v_perm_b32 v155, v34, v30, s21
    v_mfma_f32_16x16x32_bf16 v[172:175], v[36:39], v[148:151], v[172:175]
    v_perm_b32 v148, v11, v7, s20
    v_perm_b32 v149, v19, v15, s20
    v_perm_b32 v150, v27, v23, s20
    v_perm_b32 v151, v35, v31, s20
    v_mfma_f32_16x16x32_bf16 v[176:179], v[36:39], v[152:155], v[176:179]
    v_perm_b32 v152, v11, v7, s21
    v_perm_b32 v153, v19, v15, s21
    v_perm_b32 v154, v27, v23, s21
    v_perm_b32 v155, v35, v31, s21
    v_mfma_f32_16x16x32_bf16 v[180:183], v[36:39], v[148:151], v[180:183]
    s_nop 1
    v_mfma_f32_16x16x32_bf16 v[184:187], v[36:39], v[152:155], v[184:187]
    s_branch L_loopdone
L_dr_3:
    buffer_load_dwordx4 v[194:197], v191, s[64:67], 0 offen sc1
    s_waitcnt vmcnt(19)
    v_perm_b32 v148, v116, v112, s20
    v_perm_b32 v149, v124, v120, s20
    v_perm_b32 v150, v132, v128, s20
    v_perm_b32 v151, v140, v136, s20
    v_perm_b32 v152, v116, v112, s21
    v_perm_b32 v153, v124, v120, s21
    v_perm_b32 v154, v132, v128, s21
    v_perm_b32 v155, v140, v136, s21
    v_mfma_f32_16x16x32_bf16 v[156:159], v[144:147], v[148:151], v[156:159]
    v_perm_b32 v148, v117, v113, s20
    v_perm_b32 v149, v125, v121, s20
    v_perm_b32 v150, v133, v129, s20
    v_perm_b32 v151, v141, v137, s20
    v_mfma_f32_16x16x32_bf16 v[160:163], v[144:147], v[152:155], v[160:163]
    v_perm_b32 v152, v117, v113, s21
    v_perm_b32 v153, v125, v121, s21
    v_perm_b32 v154, v133, v129, s21
    v_perm_b32 v155, v141, v137, s21
    v_mfma_f32_16x16x32_bf16 v[164:167], v[144:147], v[148:151], v[164:167]
    v_perm_b32 v148, v118, v114, s20
    v_perm_b32 v149, v126, v122, s20
    v_perm_b32 v150, v134, v130, s20
    v_perm_b32 v151, v142, v138, s20
    v_mfma_f32_16x16x32_bf16 v[168:171], v[144:147], v[152:155], v[168:171]
    v_perm_b32 v152, v118, v114, s21
    v_perm_b32 v153, v126, v122, s21
    v_perm_b32 v154, v134, v130, s21
    v_perm_b32 v155, v142, v138, s21
    v_mfma_f32_16x16x32_bf16 v[172:175], v[144:147], v[148:151], v[172:175]
    v_perm_b32 v148, v119, v115, s20
    v_perm_b32 v149, v127, v123, s20
    v_perm_b32 v150, v135, v131, s20
    v_perm_b32 v151, v143, v139, s20
    v_mfma_f32_16x16x32_bf16 v[176:179], v[144:147], v[152:155], v[176:179]
    v_perm_b32 v152, v119, v115, s21
    v_perm_b32 v153, v127, v123, s21
    v_perm_b32 v154, v135, v131, s21
    v_perm_b32 v155, v143, v139, s21
    v_mfma_f32_16x16x32_bf16 v[180:183], v[144:147], v[148:151], v[180:183]
    s_nop 1
    v_mfma_f32_16x16x32_bf16 v[184:187], v[144:147], v[152:155], v[184:187]
    s_waitcnt vmcnt(10)
    v_perm_b32 v148, v8, v4, s20
    v_perm_b32 v149, v16, v12, s20
    v_perm_b32 v150, v24, v20, s20
    v_perm_b32 v151, v32, v28, s20
    v_perm_b32 v152, v8, v4, s21
    v_perm_b32 v153, v16, v12, s21
    v_perm_b32 v154, v24, v20, s21
    v_perm_b32 v155, v32, v28, s21
    v_mfma_f32_16x16x32_bf16 v[156:159], v[36:39], v[148:151], v[156:159]
    v_perm_b32 v148, v9, v5, s20
    v_perm_b32 v149, v17, v13, s20
    v_perm_b32 v150, v25, v21, s20
    v_perm_b32 v151, v33, v29, s20
    v_mfma_f32_16x16x32_bf16 v[160:163], v[36:39], v[152:155], v[160:163]
    v_perm_b32 v152, v9, v5, s21
    v_perm_b32 v153, v17, v13, s21
    v_perm_b32 v154, v25, v21, s21
    v_perm_b32 v155, v33, v29, s21
    v_mfma_f32_16x16x32_bf16 v[164:167], v[36:39], v[148:151], v[164:167]
    v_perm_b32 v148, v10, v6, s20
    v_perm_b32 v149, v18, v14, s20
    v_perm_b32 v150, v26, v22, s20
    v_perm_b32 v151, v34, v30, s20
    v_mfma_f32_16x16x32_bf16 v[168:171], v[36:39], v[152:155], v[168:171]
    v_perm_b32 v152, v10, v6, s21
    v_perm_b32 v153, v18, v14, s21
    v_perm_b32 v154, v26, v22, s21
    v_perm_b32 v155, v34, v30, s21
    v_mfma_f32_16x16x32_bf16 v[172:175], v[36:39], v[148:151], v[172:175]
    v_perm_b32 v148, v11, v7, s20
    v_perm_b32 v149, v19, v15, s20
    v_perm_b32 v150, v27, v23, s20
    v_perm_b32 v151, v35, v31, s20
    v_mfma_f32_16x16x32_bf16 v[176:179], v[36:39], v[152:155], v[176:179]
    v_perm_b32 v152, v11, v7, s21
    v_perm_b32 v153, v19, v15, s21
    v_perm_b32 v154, v27, v23, s21
    v_perm_b32 v155, v35, v31, s21
    v_mfma_f32_16x16x32_bf16 v[180:183], v[36:39], v[148:151], v[180:183]
    s_nop 1
    v_mfma_f32_16x16x32_bf16 v[184:187], v[36:39], v[152:155], v[184:187]
    s_waitcnt vmcnt(1)
    v_perm_b32 v148, v44, v40, s20
    v_perm_b32 v149, v52, v48, s20
    v_perm_b32 v150, v60, v56, s20
    v_perm_b32 v151, v68, v64, s20
    v_perm_b32 v152, v44, v40, s21
    v_perm_b32 v153, v52, v48, s21
    v_perm_b32 v154, v60, v56, s21
    v_perm_b32 v155, v68, v64, s21
    v_mfma_f32_16x16x32_bf16 v[156:159], v[72:75], v[148:151], v[156:159]
    v_perm_b32 v148, v45, v41, s20
    v_perm_b32 v149, v53, v49, s20
    v_perm_b32 v150, v61, v57, s20
    v_perm_b32 v151, v69, v65, s20
    v_mfma_f32_16x16x32_bf16 v[160:163], v[72:75], v[152:155], v[160:163]
    v_perm_b32 v152, v45, v41, s21
    v_perm_b32 v153, v53, v49, s21
    v_perm_b32 v154, v61, v57, s21
    v_perm_b32 v155, v69, v65, s21
    v_mfma_f32_16x16x32_bf16 v[164:167], v[72:75], v[148:151], v[164:167]
    v_perm_b32 v148, v46, v42, s20
    v_perm_b32 v149, v54, v50, s20
    v_perm_b32 v150, v62, v58, s20
    v_perm_b32 v151, v70, v66, s20
    v_mfma_f32_16x16x32_bf16 v[168:171], v[72:75], v[152:155], v[168:171]
    v_perm_b32 v152, v46, v42, s21
    v_perm_b32 v153, v54, v50, s21
    v_perm_b32 v154, v62, v58, s21
    v_perm_b32 v155, v70, v66, s21
    v_mfma_f32_16x16x32_bf16 v[172:175], v[72:75], v[148:151], v[172:175]
    v_perm_b32 v148, v47, v43, s20
    v_perm_b32 v149, v55, v51, s20
    v_perm_b32 v150, v63, v59, s20
    v_perm_b32 v151, v71, v67, s20
    v_mfma_f32_16x16x32_bf16 v[176:179], v[72:75], v[152:155], v[176:179]
    v_perm_b32 v152, v47, v43, s21
    v_perm_b32 v153, v55, v51, s21
    v_perm_b32 v154, v63, v59, s21
    v_perm_b32 v155, v71, v67, s21
    v_mfma_f32_16x16x32_bf16 v[180:183], v[72:75], v[148:151], v[180:183]
    s_nop 1
    v_mfma_f32_16x16x32_bf16 v[184:187], v[72:75], v[152:155], v[184:187]
L_loopdone:
    v_and_b32 v4, 15, v0
    v_lshrrev_b32 v5, 4, v0
    s_cmp_lg_u32 s33, 0
    s_cbranch_scc1 L_vend
    s_waitcnt vmcnt(0)
    v_lshlrev_b32 v8, 16, v194
    v_and_b32 v9, 0xffff0000, v194
    v_lshlrev_b32 v10, 16, v195
    v_and_b32 v11, 0xffff0000, v195
    v_lshlrev_b32 v12, 16, v196
    v_and_b32 v13, 0xffff0000, v196
    v_lshlrev_b32 v14, 16, v197
    v_and_b32 v15, 0xffff0000, v197
    v_mul_f32 v16, v8, v156
    v_mul_f32 v17, v8, v157
    v_mul_f32 v18, v8, v158
    v_mul_f32 v19, v8, v159
    v_fmac_f32 v16, v9, v160
    v_fmac_f32 v17, v9, v161
    v_fmac_f32 v18, v9, v162
    v_fmac_f32 v19, v9, v163
    v_fmac_f32 v16, v10, v164
    v_fmac_f32 v17, v10, v165
    v_fmac_f32 v18, v10, v166
    v_fmac_f32 v19, v10, v167
    v_fmac_f32 v16, v11, v168
    v_fmac_f32 v17, v11, v169
    v_fmac_f32 v18, v11, v170
    v_fmac_f32 v19, v11, v171
    v_fmac_f32 v16, v12, v172
    v_fmac_f32 v17, v12, v173
    v_fmac_f32 v18, v12, v174
    v_fmac_f32 v19, v12, v175
    v_fmac_f32 v16, v13, v176
    v_fmac_f32 v17, v13, v177
    v_fmac_f32 v18, v13, v178
    v_fmac_f32 v19, v13, v179
    v_fmac_f32 v16, v14, v180
    v_fmac_f32 v17, v14, v181
    v_fmac_f32 v18, v14, v182
    v_fmac_f32 v19, v14, v183
    v_fmac_f32 v16, v15, v184
    v_fmac_f32 v17, v15, v185
    v_fmac_f32 v18, v15, v186
    v_fmac_f32 v19, v15, v187
    s_nop 1
    v_add_f32_dpp v16, v16, v16 row_ror:8 row_mask:0xf bank_mask:0xf
    v_add_f32_dpp v17, v17, v17 row_ror:8 row_mask:0xf bank_mask:0xf
    v_add_f32_dpp v18, v18, v18 row_ror:8 row_mask:0xf bank_mask:0xf
    v_add_f32_dpp v19, v19, v19 row_ror:8 row_mask:0xf bank_mask:0xf
    s_nop 1
    v_add_f32_dpp v16, v16, v16 row_ror:4 row_mask:0xf bank_mask:0xf
    v_add_f32_dpp v17, v17, v17 row_ror:4 row_mask:0xf bank_mask:0xf
    v_add_f32_dpp v18, v18, v18 row_ror:4 row_mask:0xf bank_mask:0xf
    v_add_f32_dpp v19, v19, v19 row_ror:4 row_mask:0xf bank_mask:0xf
    s_nop 1
    v_add_f32_dpp v16, v16, v16 row_ror:2 row_mask:0xf bank_mask:0xf
    v_add_f32_dpp v17, v17, v17 row_ror:2 row_mask:0xf bank_mask:0xf
    v_add_f32_dpp v18, v18, v18 row_ror:2 row_mask:0xf bank_mask:0xf
    v_add_f32_dpp v19, v19, v19 row_ror:2 row_mask:0xf bank_mask:0xf
    s_nop 1
    v_add_f32_dpp v16, v16, v16 row_ror:1 row_mask:0xf bank_mask:0xf
    v_add_f32_dpp v17, v17, v17 row_ror:1 row_mask:0xf bank_mask:0xf
    v_add_f32_dpp v18, v18, v18 row_ror:1 row_mask:0xf bank_mask:0xf
    v_add_f32_dpp v19, v19, v19 row_ror:1 row_mask:0xf bank_mask:0xf
    v_lshlrev_b32 v6, 4, v5
    v_cmp_eq_u32 vcc, 0, v4
    s_and_saveexec_b64 s[48:49], vcc
    ds_add_f32 v6, v16 offset:32
    ds_add_f32 v6, v17 offset:36
    ds_add_f32 v6, v18 offset:40
    ds_add_f32 v6, v19 offset:44
    s_mov_b64 exec, 1
    v_mov_b32 v8, 16
    v_mov_b32 v9, 1
    ds_add_rtn_u32 v9, v8, v9
    s_mov_b64 exec, -1
    s_waitcnt lgkmcnt(0)
    v_readfirstlane_b32 s36, v9
    s_nop 3
    s_cmp_lg_u32 s36, 3
    s_cbranch_scc1 L_fin
    v_lshlrev_b32 v6, 2, v4
    ds_read_b32 v7, v6 offset:32
    s_lshl_b32 s36, s30, 6
    v_add_u32 v6, s36, v6
    s_waitcnt lgkmcnt(0)
    s_mov_b64 exec, 0xffff
    global_store_dword v6, v7, s[54:55] offset:1536 sc1
    s_mov_b64 exec, -1
    s_waitcnt vmcnt(0)
    s_mov_b32 s36, 1
    s_atomic_add s36, s[54:55], 512 glc
    s_waitcnt lgkmcnt(0)
    s_cmp_lg_u32 s36, 7
    s_cbranch_scc1 L_fin
    v_lshlrev_b32 v6, 2, v0
    global_load_dword v8, v6, s[54:55] offset:1536 sc1
    global_load_dword v9, v6, s[54:55] offset:1792 sc1
    v_xor_b32 v6, 16, v0
    v_lshlrev_b32 v6, 2, v6
    v_xor_b32 v7, 32, v0
    v_lshlrev_b32 v7, 2, v7
    s_waitcnt vmcnt(0)
    v_add_f32 v8, v8, v9
    ds_bpermute_b32 v9, v6, v8
    s_waitcnt lgkmcnt(0)
    v_add_f32 v8, v8, v9
    ds_bpermute_b32 v9, v7, v8
    s_waitcnt lgkmcnt(0)
    v_add_f32 v8, v8, v9
    v_cvt_pk_bf16_f32 v8, v8, v8
    v_lshlrev_b32 v8, 16, v8
    v_mul_f32 v8, 0x3db504f3, v8
    v_cvt_pk_bf16_f32 v8, v8, v8
    v_lshlrev_b32 v8, 16, v8
    v_mov_b32 v9, v8
    s_nop 1
    v_max_f32_dpp v9, v9, v9 row_ror:8 row_mask:0xf bank_mask:0xf
    s_nop 1
    v_max_f32_dpp v9, v9, v9 row_ror:4 row_mask:0xf bank_mask:0xf
    s_nop 1
    v_max_f32_dpp v9, v9, v9 row_ror:2 row_mask:0xf bank_mask:0xf
    s_nop 1
    v_max_f32_dpp v9, v9, v9 row_ror:1 row_mask:0xf bank_mask:0xf
    v_sub_f32 v8, v8, v9
    v_mul_f32 v8, 0x3fb8aa3b, v8
    v_exp_f32 v8, v8
    s_nop 0
    v_mov_b32 v9, v8
    s_nop 1
    v_add_f32_dpp v9, v9, v9 row_ror:8 row_mask:0xf bank_mask:0xf
    s_nop 1
    v_add_f32_dpp v9, v9, v9 row_ror:4 row_mask:0xf bank_mask:0xf
    s_nop 1
    v_add_f32_dpp v9, v9, v9 row_ror:2 row_mask:0xf bank_mask:0xf
    s_nop 1
    v_add_f32_dpp v9, v9, v9 row_ror:1 row_mask:0xf bank_mask:0xf
    v_rcp_f32 v9, v9
    s_nop 0
    v_mul_f32 v8, v8, v9
    v_cvt_pk_bf16_f32 v8, v8, v8
    v_lshlrev_b32 v8, 16, v8
    v_lshlrev_b32 v6, 2, v4
    s_mov_b64 exec, 0xffff
    global_store_dword v6, v8, s[54:55] offset:1024 sc1
    s_branch L_fin
L_vend:
    s_mov_b32 s36, 30000
L_pchk:
    s_waitcnt vmcnt(0)
    v_cmp_eq_u32 vcc, -1, v194
    v_cmp_eq_u32 s[48:49], -1, v195
    s_or_b64 vcc, vcc, s[48:49]
    v_cmp_eq_u32 s[48:49], -1, v196
    s_or_b64 vcc, vcc, s[48:49]
    v_cmp_eq_u32 s[48:49], -1, v197
    s_or_b64 vcc, vcc, s[48:49]
    s_cbranch_vccz L_pok
    s_sub_u32 s36, s36, 1
    s_cbranch_scc1 L_pok
    s_sleep 8
    buffer_load_dwordx4 v[194:197], v191, s[64:67], 0 offen sc1
    s_branch L_pchk
L_pok:
    v_mul_f32 v8, v194, v156
    v_mul_f32 v9, v194, v160
    v_mul_f32 v10, v194, v164
    v_mul_f32 v11, v194, v168
    v_mul_f32 v12, v194, v172
    v_mul_f32 v13, v194, v176
    v_mul_f32 v14, v194, v180
    v_mul_f32 v15, v194, v184
    v_fmac_f32 v8, v195, v157
    v_fmac_f32 v9, v195, v161
    v_fmac_f32 v10, v195, v165
    v_fmac_f32 v11, v195, v169
    v_fmac_f32 v12, v195, v173
    v_fmac_f32 v13, v195, v177
    v_fmac_f32 v14, v195, v181
    v_fmac_f32 v15, v195, v185
    v_fmac_f32 v8, v196, v158
    v_fmac_f32 v9, v196, v162
    v_fmac_f32 v10, v196, v166
    v_fmac_f32 v11, v196, v170
    v_fmac_f32 v12, v196, v174
    v_fmac_f32 v13, v196, v178
    v_fmac_f32 v14, v196, v182
    v_fmac_f32 v15, v196, v186
    v_fmac_f32 v8, v197, v159
    v_fmac_f32 v9, v197, v163
    v_fmac_f32 v10, v197, v167
    v_fmac_f32 v11, v197, v171
    v_fmac_f32 v12, v197, v175
    v_fmac_f32 v13, v197, v179
    v_fmac_f32 v14, v197, v183
    v_fmac_f32 v15, v197, v187
    s_nop 1
    v_permlane32_swap_b32 v8, v12
    v_permlane32_swap_b32 v10, v14
    v_permlane32_swap_b32 v9, v13
    v_permlane32_swap_b32 v11, v15
    s_nop 1
    v_add_f32 v8, v8, v12
    v_add_f32 v10, v10, v14
    v_add_f32 v9, v9, v13
    v_add_f32 v11, v11, v15
    s_nop 1
    v_permlane16_swap_b32 v8, v10
    v_permlane16_swap_b32 v9, v11
    s_nop 1
    v_add_f32 v8, v8, v10
    v_add_f32 v9, v9, v11
    v_lshlrev_b32 v6, 3, v0
    s_lshl_b32 s36, s34, 9
    v_add_u32 v7, s36, v6
    ds_write_b64 v7, v[8:9] offset:128
    s_waitcnt lgkmcnt(0)
    s_barrier
    s_cmp_lg_u32 s3, 4
    s_cbranch_scc1 L_fin
    ds_read_b64 v[10:11], v6 offset:128
    ds_read_b64 v[12:13], v6 offset:640
    ds_read_b64 v[14:15], v6 offset:1152
    ds_read_b64 v[16:17], v6 offset:1664
    s_waitcnt lgkmcnt(3)
    v_mov_b32 v8, v10
    v_mov_b32 v9, v11
    s_waitcnt lgkmcnt(2)
    v_add_f32 v8, v8, v12
    v_add_f32 v9, v9, v13
    s_waitcnt lgkmcnt(1)
    v_add_f32 v8, v8, v14
    v_add_f32 v9, v9, v15
    s_waitcnt lgkmcnt(0)
    v_add_f32 v8, v8, v16
    v_add_f32 v9, v9, v17
    s_cmp_eq_u32 s30, 0
    s_cbranch_scc1 L_final
    v_mov_b32 v10, 0x7fc00000
    v_cmp_eq_u32 vcc, -1, v8
    v_cmp_eq_u32 s[48:49], -1, v9
    s_lshl_b32 s36, s30, 9
    v_add_u32 v6, s36, v6
    v_cndmask_b32 v8, v8, v10, vcc
    v_cndmask_b32 v9, v9, v10, s[48:49]
    global_store_dwordx2 v6, v[8:9], s[54:55] offset:2048 sc1
    s_branch L_fin
L_final:
    v_add_u32 v6, 2048, v6
    s_mov_b32 s36, 30000
L_opoll:
    global_load_dwordx2 v[12:13], v6, s[54:55] offset:512 sc1
    global_load_dwordx2 v[14:15], v6, s[54:55] offset:1024 sc1
    global_load_dwordx2 v[16:17], v6, s[54:55] offset:1536 sc1
    global_load_dwordx2 v[18:19], v6, s[54:55] offset:2048 sc1
    global_load_dwordx2 v[20:21], v6, s[54:55] offset:2560 sc1
    global_load_dwordx2 v[22:23], v6, s[54:55] offset:3072 sc1
    global_load_dwordx2 v[24:25], v6, s[54:55] offset:3584 sc1
    s_waitcnt vmcnt(0)
    v_cmp_eq_u32 vcc, -1, v12
    v_cmp_eq_u32 s[48:49], -1, v13
    s_or_b64 vcc, vcc, s[48:49]
    v_cmp_eq_u32 s[48:49], -1, v14
    s_or_b64 vcc, vcc, s[48:49]
    v_cmp_eq_u32 s[48:49], -1, v15
    s_or_b64 vcc, vcc, s[48:49]
    v_cmp_eq_u32 s[48:49], -1, v16
    s_or_b64 vcc, vcc, s[48:49]
    v_cmp_eq_u32 s[48:49], -1, v17
    s_or_b64 vcc, vcc, s[48:49]
    v_cmp_eq_u32 s[48:49], -1, v18
    s_or_b64 vcc, vcc, s[48:49]
    v_cmp_eq_u32 s[48:49], -1, v19
    s_or_b64 vcc, vcc, s[48:49]
    v_cmp_eq_u32 s[48:49], -1, v20
    s_or_b64 vcc, vcc, s[48:49]
    v_cmp_eq_u32 s[48:49], -1, v21
    s_or_b64 vcc, vcc, s[48:49]
    v_cmp_eq_u32 s[48:49], -1, v22
    s_or_b64 vcc, vcc, s[48:49]
    v_cmp_eq_u32 s[48:49], -1, v23
    s_or_b64 vcc, vcc, s[48:49]
    v_cmp_eq_u32 s[48:49], -1, v24
    s_or_b64 vcc, vcc, s[48:49]
    v_cmp_eq_u32 s[48:49], -1, v25
    s_or_b64 vcc, vcc, s[48:49]
    s_cbranch_vccz L_ook
    s_sub_u32 s36, s36, 1
    s_cbranch_scc1 L_ook
    s_sleep 2
    s_branch L_opoll
L_ook:
    v_add_f32 v8, v8, v12
    v_add_f32 v9, v9, v13
    v_add_f32 v8, v8, v14
    v_add_f32 v9, v9, v15
    v_add_f32 v8, v8, v16
    v_add_f32 v9, v9, v17
    v_add_f32 v8, v8, v18
    v_add_f32 v9, v9, v19
    v_add_f32 v8, v8, v20
    v_add_f32 v9, v9, v21
    v_add_f32 v8, v8, v22
    v_add_f32 v9, v9, v23
    v_add_f32 v8, v8, v24
    v_add_f32 v9, v9, v25
    v_cvt_pk_bf16_f32 v8, v8, v9
    s_lshl_b32 s36, s32, 8
    s_add_u32 s12, s60, s36
    s_addc_u32 s13, s61, 0
    s_and_b32 s13, s13, 0xffff
    s_mov_b32 s14, 256
    s_mov_b32 s15, 0x20000
    v_lshlrev_b32 v6, 4, v4
    v_lshl_add_u32 v6, v5, 2, v6
    buffer_store_dword v8, v6, s[12:15], 0 offen
L_fin:
L_done:
    s_endpgm
.section .rodata,"a"
.p2align 6
.amdhsa_kernel standalone__low_rank_proj_linformer__decode_kernel
  .amdhsa_next_free_vgpr 198
  .amdhsa_next_free_sgpr 96
  .amdhsa_accum_offset 200
  .amdhsa_group_segment_fixed_size 0
  .amdhsa_kernarg_size 64
  .amdhsa_user_sgpr_count 2
  .amdhsa_user_sgpr_kernarg_segment_ptr 1
  .amdhsa_system_sgpr_workgroup_id_x 1
.end_amdhsa_kernel
```
